```python
import torch

def _softmax(x, axis=-1):
    return torch.softmax(x, dim=axis)
def _gelu(x):
    return torch.nn.functional.gelu(x, approximate="tanh")
def _silu(x):
    return torch.nn.functional.silu(x)
def _sigmoid(x):
    return torch.sigmoid(x)
def _layernorm(x, axis=-1, eps=1e-5):
    m = x.mean(dim=axis, keepdim=True)
    v = x.var(dim=axis, keepdim=True, unbiased=False)
    return (x - m) / torch.sqrt(v + eps)
def _scatter_add(tgt, idx, src, axis=0):
    return tgt.clone().index_add_(axis, idx, src)
def _segment_sum(src, seg, n):
    out = torch.zeros((n,) + src.shape[1:], dtype=src.dtype)
    return out.index_add_(0, seg, src)
def _pad(x, pw):
    flat = tuple(v for pair in reversed(pw) for v in pair)
    return torch.nn.functional.pad(x, flat)

kernel_name = 'standalone__low_rank_proj_linformer__sampling'

def setup_inputs():

    _w = (lambda a: (lambda t: t.to(torch.bfloat16) if t.is_floating_point() else t)(torch.as_tensor(a)))
    B, H, Sq, Skv, Dh, R = 16, 32, 16, 4096, 128, 16
    return {
        "q": _w((lambda *s: torch.randn(*s, dtype=torch.bfloat16) * 0.8)(B, H, Sq, Dh)),
        "k": _w((lambda *s: torch.randn(*s, dtype=torch.bfloat16) * 0.8)(B, H, Skv, Dh)),
        "v": _w((lambda *s: torch.randn(*s, dtype=torch.bfloat16) * 0.05)(B, H, Skv, Dh)),
        "e_proj": _w((lambda *s: torch.randn(*s, dtype=torch.bfloat16) * 0.8)(R, Skv) * (Skv ** -0.5)),
        "f_proj": _w((lambda *s: torch.randn(*s, dtype=torch.bfloat16) * 0.05)(R, Skv) * (Skv ** -0.5)),
    }

def reference(q, k, v, e_proj, f_proj):
    B, H, Sq, Dh = q.shape
    kp = torch.einsum("rn,bhnd->bhrd", e_proj, k)
    vp = torch.einsum("rn,bhnd->bhrd", f_proj, v)
    scores = torch.einsum("bhqd,bhrd->bhqr", q, kp) * (Dh ** -0.5)
    p = _softmax(scores, axis=-1)
    o = torch.einsum("bhqr,bhrd->bhqd", p, vp)
    return o
```

```asm
; @launch grid=(256,1,1) block=(256,1,1) lds=74240
.amdgcn_target "amdgcn-amd-amdhsa--gfx950"
.text
.globl standalone__low_rank_proj_linformer__sampling_kernel
.p2align 8
.type standalone__low_rank_proj_linformer__sampling_kernel,@function
standalone__low_rank_proj_linformer__sampling_kernel:
    s_cmp_ge_u32 s2, 256
    s_cbranch_scc1 L_end
    s_load_dwordx16 s[4:19], s[0:1], 0
    s_memrealtime s[72:73]
    s_getpc_b64 s[52:53]
L_pc:
    v_lshlrev_b32 v3, 6, v0
    v_min_u32 v3, L_end-L_pc, v3
    global_load_dword v163, v3, s[52:53]
    v_lshrrev_b32 v6, 6, v0
    v_and_b32 v0, 63, v0
    v_readfirstlane_b32 s22, v6
    v_and_b32 v6, 15, v0
    v_lshrrev_b32 v7, 4, v0
    v_lshlrev_b32 v1, 4, v6
    v_lshl_add_u32 v1, v7, 11, v1
    v_lshlrev_b32 v2, 13, v6
    v_lshl_add_u32 v2, v7, 4, v2
    s_lshl_b32 s23, s22, 13
    s_mov_b32 s56, 0
    s_bfe_u32 s52, s2, 0x10003
    s_lshl_b32 s52, s52, 16
    s_xor_b32 s23, s23, s52
    s_mov_b32 s79, s23
    s_lshr_b32 s24, s23, 7
    s_and_b32 s50, s2, 0xc0
    s_lshl_b32 s51, s2, 1
    s_and_b32 s51, s51, 0x2
    s_or_b32 s50, s50, s51
    s_lshr_b32 s51, s2, 2
    s_and_b32 s51, s51, 0xc
    s_or_b32 s50, s50, s51
    s_lshl_b32 s51, s2, 2
    s_and_b32 s51, s51, 0x10
    s_or_b32 s50, s50, s51
    s_lshr_b32 s51, s2, 3
    s_and_b32 s51, s51, 0x1
    s_or_b32 s50, s50, s51
    s_lshl_b32 s51, s2, 4
    s_and_b32 s51, s51, 0x20
    s_or_b32 s50, s50, s51
    s_lshl_b32 s48, s50, 21
    s_mov_b32 s30, 0x100000
    s_mov_b32 s31, 0x20000
    s_mov_b32 s34, s31
    s_mov_b32 s35, s31
    s_waitcnt lgkmcnt(0)
    s_add_u32 s28, s6, s48
    s_addc_u32 s29, s7, 0
    s_mov_b32 s32, s10
    s_mov_b32 s33, s11
    buffer_load_dwordx4 a[16:19], v2, s[32:35], s24 offen sc0
    buffer_load_dwordx4 v[96:99], v1, s[28:31], s23 offen offset:0 nt
    buffer_load_dwordx4 v[100:103], v1, s[28:31], s23 offen offset:256 nt
    s_barrier
    buffer_load_dwordx4 v[104:107], v1, s[28:31], s23 offen offset:512 nt
    buffer_load_dwordx4 v[108:111], v1, s[28:31], s23 offen offset:768 nt
    s_barrier
    buffer_load_dwordx4 v[112:115], v1, s[28:31], s23 offen offset:1024 nt
    buffer_load_dwordx4 v[116:119], v1, s[28:31], s23 offen offset:1280 nt
    s_barrier
    buffer_load_dwordx4 v[120:123], v1, s[28:31], s23 offen offset:1536 nt
    buffer_load_dwordx4 v[124:127], v1, s[28:31], s23 offen offset:1792 nt
    s_or_b32 s56, s56, 0x7f00
    s_add_u32 s56, s56, 0x8000
    s_andn2_b32 s56, s56, 0x7f00
    s_xor_b32 s23, s56, s79
    s_lshr_b32 s24, s23, 7
    s_barrier
    buffer_load_dwordx4 v[128:131], v1, s[28:31], s23 offen offset:0 nt
    buffer_load_dwordx4 a[20:23], v2, s[32:35], s24 offen sc0
    buffer_load_dwordx4 v[132:135], v1, s[28:31], s23 offen offset:256 nt
    s_barrier
    buffer_load_dwordx4 v[136:139], v1, s[28:31], s23 offen offset:512 nt
    buffer_load_dwordx4 v[140:143], v1, s[28:31], s23 offen offset:768 nt
    s_barrier
    buffer_load_dwordx4 v[144:147], v1, s[28:31], s23 offen offset:1024 nt
    buffer_load_dwordx4 v[148:151], v1, s[28:31], s23 offen offset:1280 nt
    s_barrier
    buffer_load_dwordx4 v[152:155], v1, s[28:31], s23 offen offset:1536 nt
    buffer_load_dwordx4 v[156:159], v1, s[28:31], s23 offen offset:1792 nt
    s_mov_b32 s20, 0x05040100
    s_mov_b32 s21, 0x07060302
    s_lshl_b32 s49, s50, 13
    s_mov_b32 s42, 8192
    s_mov_b32 s43, 0x20000
    s_mov_b32 s46, 8192
    s_mov_b32 s47, 0x20000
    s_mov_b32 s65, 0
    s_mov_b32 s57, 0
    s_mov_b32 s78, 0
    s_mov_b32 s66, 17280
    s_mov_b32 s67, 13888
    s_mov_b32 s74, 0
    s_mov_b32 s76, 3472
    s_mov_b32 s77, 0
    s_lshr_b32 s54, s2, 3
    s_and_b32 s54, s54, 1
    s_mov_b32 s80, 0x7fffffff
    s_mov_b32 s55, 0
    s_cmp_eq_u32 s22, 1
    s_cselect_b32 s80, 1, s80
    s_cselect_b32 s55, 136, s55
    s_cmp_eq_u32 s22, 2
    s_cselect_b32 s80, 9, s80
    s_cselect_b32 s55, 128, s55
    s_cmp_eq_u32 s22, 3
    s_cselect_b32 s80, 25, s80
    s_cselect_b32 s55, 64, s55
    s_cmp_eq_u32 s22, 0
    s_cselect_b32 s80, 41, s80
    s_cselect_b32 s55, 192, s55
    v_mov_b32 v94, s55
    s_cmp_lg_u32 s80, 0x7fffffff
    s_cselect_b32 s54, s54, 0
    s_add_u32 s80, s80, s54
    s_cmp_lt_u32 s2, 16
    s_cselect_b32 s80, s80, 0x7fffffff
    s_mov_b32 s64, 1
    s_mov_b32 s81, 0
    s_mov_b32 s68, 0
    s_mov_b32 s69, 0
    s_mov_b32 s70, 0
    s_mov_b32 s71, 0
    s_mov_b32 s27, 0
    s_mov_b32 s26, 0
    s_add_u32 s36, s8, s48
    s_addc_u32 s37, s9, 0
    s_mov_b32 s38, s12
    s_mov_b32 s39, s13
    s_add_u32 s40, s4, s49
    s_addc_u32 s41, s5, 0
    s_add_u32 s44, s14, s49
    s_addc_u32 s45, s15, 0
    v_lshlrev_b32 v72, 4, v0
    s_lshr_b32 s54, s22, 1
    s_lshl_b32 s54, s54, 12
    s_bfe_u32 s50, s2, 0x50003
    s_lshl_b32 s50, s50, 2
    s_add_u32 s50, s50, s22
    s_lshl_b32 s50, s50, 10
    v_lshlrev_b32 v73, 4, v0
    v_add_u32 v73, s50, v73
    v_lshlrev_b32 v5, 8, v6
    v_lshl_add_u32 v5, v7, 4, v5
    s_lshl_b32 s50, s22, 6
    v_add_u32 v5, s50, v5
    v_and_b32 v4, 3, v6
    v_mul_u32_u24 v4, 1088, v4
    v_lshrrev_b32 v6, 2, v6
    v_lshl_add_u32 v6, v7, 4, v6
    v_lshl_add_u32 v4, v6, 4, v4
    s_lshl_b32 s50, s22, 6
    s_add_u32 s50, s50, 35328
    v_add_u32 v4, s50, v4
    v_lshlrev_b32 v6, 4, v0
    s_mul_i32 s50, s22, 8704
    s_add_u32 s50, s50, 512
    v_add_u32 v3, s50, v6
    v_mov_b32 v8, 0
    v_mov_b32 v9, 0
    v_mov_b32 v10, 0
    v_mov_b32 v11, 0
    v_mov_b32 v12, 0
    v_mov_b32 v13, 0
    v_mov_b32 v14, 0
    v_mov_b32 v15, 0
    v_mov_b32 v16, 0
    v_mov_b32 v17, 0
    v_mov_b32 v18, 0
    v_mov_b32 v19, 0
    v_mov_b32 v20, 0
    v_mov_b32 v21, 0
    v_mov_b32 v22, 0
    v_mov_b32 v23, 0
    v_mov_b32 v24, 0
    v_mov_b32 v25, 0
    v_mov_b32 v26, 0
    v_mov_b32 v27, 0
    v_mov_b32 v28, 0
    v_mov_b32 v29, 0
    v_mov_b32 v30, 0
    v_mov_b32 v31, 0
    v_mov_b32 v32, 0
    v_mov_b32 v33, 0
    v_mov_b32 v34, 0
    v_mov_b32 v35, 0
    v_mov_b32 v36, 0
    v_mov_b32 v37, 0
    v_mov_b32 v38, 0
    v_mov_b32 v39, 0
L_outer:
    s_mov_b32 s25, 16
L_body_post:
    s_waitcnt vmcnt(15)
    v_perm_b32 v40, v100, v96, s20
    v_perm_b32 v44, v100, v96, s21
    v_perm_b32 v48, v101, v97, s20
    v_perm_b32 v52, v101, v97, s21
    v_perm_b32 v56, v102, v98, s20
    v_perm_b32 v60, v102, v98, s21
    v_perm_b32 v64, v103, v99, s20
    v_perm_b32 v68, v103, v99, s21
    s_waitcnt vmcnt(13)
    v_perm_b32 v41, v108, v104, s20
    v_perm_b32 v45, v108, v104, s21
    v_perm_b32 v49, v109, v105, s20
    v_perm_b32 v53, v109, v105, s21
    v_perm_b32 v57, v110, v106, s20
    v_perm_b32 v61, v110, v106, s21
    v_perm_b32 v65, v111, v107, s20
    v_perm_b32 v69, v111, v107, s21
    s_waitcnt vmcnt(11)
    v_perm_b32 v42, v116, v112, s20
    v_perm_b32 v46, v116, v112, s21
    v_perm_b32 v50, v117, v113, s20
    v_perm_b32 v54, v117, v113, s21
    v_perm_b32 v58, v118, v114, s20
    v_perm_b32 v62, v118, v114, s21
    v_perm_b32 v66, v119, v115, s20
    v_perm_b32 v70, v119, v115, s21
    s_waitcnt vmcnt(9)
    s_memrealtime s[74:75]
    v_perm_b32 v43, v124, v120, s20
    v_perm_b32 v47, v124, v120, s21
    v_perm_b32 v51, v125, v121, s20
    v_perm_b32 v55, v125, v121, s21
    v_perm_b32 v59, v126, v122, s20
    v_perm_b32 v63, v126, v122, s21
    v_perm_b32 v67, v127, v123, s20
    v_perm_b32 v71, v127, v123, s21
    s_or_b32 s56, s56, 0x7f00
    s_add_u32 s56, s56, 0x8000
    s_andn2_b32 s56, s56, 0x7f00
    s_xor_b32 s23, s56, s79
    s_lshr_b32 s24, s23, 7
    s_bitcmp1_b32 s22, 0
    s_cselect_b64 exec, 1, -1
    buffer_load_dwordx4 a[0:3], v72, s[40:43], s54 offen offset:0
    buffer_load_dwordx4 a[4:7], v72, s[40:43], s54 offen offset:1024
    buffer_load_dwordx4 a[8:11], v72, s[40:43], s54 offen offset:2048
    buffer_load_dwordx4 a[12:15], v72, s[40:43], s54 offen offset:3072
    s_mov_b64 exec, -1
    s_cmp_lt_u32 s2, 16
    s_cbranch_scc0 L_nosr
    s_cmp_eq_u32 s22, 1
    s_cbranch_scc0 L_nosr
    v_mov_b32 v92, s72
    v_mov_b32 v93, 0x100
    v_mov_b32 v91, 0
    s_mov_b64 exec, 1
    global_atomic_add_x2 v91, v[92:93], s[16:17] sc1
    s_mov_b64 exec, -1
L_nosr:
    global_load_dwordx4 v[160:163], v73, s[10:11]
    global_load_dwordx4 v[160:163], v73, s[12:13]
    s_waitcnt vmcnt(10)
    buffer_load_dwordx4 v[96:99], v1, s[28:31], s23 offen offset:0 nt
    buffer_load_dwordx4 v[100:103], v1, s[28:31], s23 offen offset:256 nt
    s_nop 1
    v_mfma_f32_16x16x32_bf16 v[8:11], a[16:19], v[40:43], v[8:11]
    v_mfma_f32_16x16x32_bf16 v[12:15], a[16:19], v[44:47], v[12:15]
    v_mfma_f32_16x16x32_bf16 v[16:19], a[16:19], v[48:51], v[16:19]
    v_mfma_f32_16x16x32_bf16 v[20:23], a[16:19], v[52:55], v[20:23]
    v_mfma_f32_16x16x32_bf16 v[24:27], a[16:19], v[56:59], v[24:27]
    v_mfma_f32_16x16x32_bf16 v[28:31], a[16:19], v[60:63], v[28:31]
    v_mfma_f32_16x16x32_bf16 v[32:35], a[16:19], v[64:67], v[32:35]
    v_mfma_f32_16x16x32_bf16 v[36:39], a[16:19], v[68:71], v[36:39]
    buffer_load_dwordx4 a[16:19], v2, s[32:35], s24 offen sc0
    v_perm_b32 v40, v132, v128, s20
    v_perm_b32 v44, v132, v128, s21
    v_perm_b32 v48, v133, v129, s20
    v_perm_b32 v52, v133, v129, s21
    v_perm_b32 v56, v134, v130, s20
    v_perm_b32 v60, v134, v130, s21
    v_perm_b32 v64, v135, v131, s20
    v_perm_b32 v68, v135, v131, s21
    s_waitcnt vmcnt(11)
    buffer_load_dwordx4 v[104:107], v1, s[28:31], s23 offen offset:512 nt
    buffer_load_dwordx4 v[108:111], v1, s[28:31], s23 offen offset:768 nt
    v_perm_b32 v41, v140, v136, s20
    v_perm_b32 v45, v140, v136, s21
    v_perm_b32 v49, v141, v137, s20
    v_perm_b32 v53, v141, v137, s21
    v_perm_b32 v57, v142, v138, s20
    v_perm_b32 v61, v142, v138, s21
    v_perm_b32 v65, v143, v139, s20
    v_perm_b32 v69, v143, v139, s21
    s_waitcnt vmcnt(11)
    buffer_load_dwordx4 v[112:115], v1, s[28:31], s23 offen offset:1024 nt
    buffer_load_dwordx4 v[116:119], v1, s[28:31], s23 offen offset:1280 nt
    s_waitcnt lgkmcnt(0)
    s_cmp_eq_u32 s57, s80
    s_cbranch_scc1 L_rp_post
L_rpr_post:
    s_cmp_eq_u32 s57, s64
    s_cbranch_scc1 L_ev_post
L_evr_post:
    s_sub_u32 s54, s74, s72
    s_lshl_b32 s54, s54, 6
    s_sub_u32 s54, s54, s66
    s_add_u32 s66, s66, s67
    s_add_u32 s57, s57, 1
    s_mov_b32 s65, 0
    s_cmp_eq_u32 s57, 63
    s_cselect_b32 s65, 3, s65
    v_perm_b32 v42, v148, v144, s20
    v_perm_b32 v46, v148, v144, s21
    v_perm_b32 v50, v149, v145, s20
    v_perm_b32 v54, v149, v145, s21
    v_perm_b32 v58, v150, v146, s20
    v_perm_b32 v62, v150, v146, s21
    v_perm_b32 v66, v151, v147, s20
    v_perm_b32 v70, v151, v147, s21
    s_waitcnt vmcnt(5)
    buffer_load_dwordx4 v[120:123], v1, s[28:31], s23 offen offset:1536 nt
    buffer_load_dwordx4 v[124:127], v1, s[28:31], s23 offen offset:1792 nt
    v_perm_b32 v43, v156, v152, s20
    v_perm_b32 v47, v156, v152, s21
    v_perm_b32 v51, v157, v153, s20
    v_perm_b32 v55, v157, v153, s21
    v_perm_b32 v59, v158, v154, s20
    v_perm_b32 v63, v158, v154, s21
    v_perm_b32 v67, v159, v155, s20
    v_perm_b32 v71, v159, v155, s21
    s_sub_u32 s25, s25, 1
L_dispatch:
    s_cmp_eq_u32 s65, 1
    s_cbranch_scc1 L_body_hi
    s_cmp_eq_u32 s65, 2
    s_cbranch_scc1 L_body_lo
    s_cmp_eq_u32 s65, 3
    s_cbranch_scc1 L_body_fin
L_body_mid:
    s_or_b32 s56, s56, 0x7f00
    s_add_u32 s56, s56, 0x8000
    s_andn2_b32 s56, s56, 0x7f00
    s_xor_b32 s23, s56, s79
    s_lshr_b32 s24, s23, 7
    s_waitcnt vmcnt(4)
    s_barrier
    buffer_load_dwordx4 v[128:131], v1, s[28:31], s23 offen offset:0 nt
    buffer_load_dwordx4 v[132:135], v1, s[28:31], s23 offen offset:256 nt
    s_nop 1
    v_mfma_f32_16x16x32_bf16 v[8:11], a[20:23], v[40:43], v[8:11]
    v_mfma_f32_16x16x32_bf16 v[12:15], a[20:23], v[44:47], v[12:15]
    v_mfma_f32_16x16x32_bf16 v[16:19], a[20:23], v[48:51], v[16:19]
    v_mfma_f32_16x16x32_bf16 v[20:23], a[20:23], v[52:55], v[20:23]
    v_mfma_f32_16x16x32_bf16 v[24:27], a[20:23], v[56:59], v[24:27]
    v_mfma_f32_16x16x32_bf16 v[28:31], a[20:23], v[60:63], v[28:31]
    v_mfma_f32_16x16x32_bf16 v[32:35], a[20:23], v[64:67], v[32:35]
    v_mfma_f32_16x16x32_bf16 v[36:39], a[20:23], v[68:71], v[36:39]
    buffer_load_dwordx4 a[20:23], v2, s[32:35], s24 offen sc0
    v_perm_b32 v40, v100, v96, s20
    v_perm_b32 v44, v100, v96, s21
    v_perm_b32 v48, v101, v97, s20
    v_perm_b32 v52, v101, v97, s21
    v_perm_b32 v56, v102, v98, s20
    v_perm_b32 v60, v102, v98, s21
    v_perm_b32 v64, v103, v99, s20
    v_perm_b32 v68, v103, v99, s21
    s_waitcnt vmcnt(5)
    s_barrier
    buffer_load_dwordx4 v[136:139], v1, s[28:31], s23 offen offset:512 nt
    buffer_load_dwordx4 v[140:143], v1, s[28:31], s23 offen offset:768 nt
    v_perm_b32 v41, v108, v104, s20
    v_perm_b32 v45, v108, v104, s21
    v_perm_b32 v49, v109, v105, s20
    v_perm_b32 v53, v109, v105, s21
    v_perm_b32 v57, v110, v106, s20
    v_perm_b32 v61, v110, v106, s21
    v_perm_b32 v65, v111, v107, s20
    v_perm_b32 v69, v111, v107, s21
    s_waitcnt vmcnt(5)
    s_barrier
    buffer_load_dwordx4 v[144:147], v1, s[28:31], s23 offen offset:1024 nt
    buffer_load_dwordx4 v[148:151], v1, s[28:31], s23 offen offset:1280 nt
    v_perm_b32 v42, v116, v112, s20
    v_perm_b32 v46, v116, v112, s21
    v_perm_b32 v50, v117, v113, s20
    v_perm_b32 v54, v117, v113, s21
    v_perm_b32 v58, v118, v114, s20
    v_perm_b32 v62, v118, v114, s21
    v_perm_b32 v66, v119, v115, s20
    v_perm_b32 v70, v119, v115, s21
    s_waitcnt vmcnt(5)
    s_barrier
    buffer_load_dwordx4 v[152:155], v1, s[28:31], s23 offen offset:1536 nt
    buffer_load_dwordx4 v[156:159], v1, s[28:31], s23 offen offset:1792 nt
    s_memrealtime s[74:75]
    v_perm_b32 v43, v124, v120, s20
    v_perm_b32 v47, v124, v120, s21
    v_perm_b32 v51, v125, v121, s20
    v_perm_b32 v55, v125, v121, s21
    v_perm_b32 v59, v126, v122, s20
    v_perm_b32 v63, v126, v122, s21
    v_perm_b32 v67, v127, v123, s20
    v_perm_b32 v71, v127, v123, s21
    s_or_b32 s56, s56, 0x7f00
    s_add_u32 s56, s56, 0x8000
    s_andn2_b32 s56, s56, 0x7f00
    s_xor_b32 s23, s56, s79
    s_cmp_eq_u32 s25, 1
    s_cbranch_scc0 L_swr_mid
    s_mov_b32 s23, s79
    s_mov_b32 s56, 0
    s_add_u32 s52, s28, 0x100000
    s_addc_u32 s53, s29, 0
    s_mov_b32 s28, s36
    s_mov_b32 s29, s37
    s_mov_b32 s36, s52
    s_mov_b32 s37, s53
    s_mov_b32 s52, s32
    s_mov_b32 s53, s33
    s_mov_b32 s32, s38
    s_mov_b32 s33, s39
    s_mov_b32 s38, s52
    s_mov_b32 s39, s53
    s_add_u32 s27, s27, 1
    s_cmp_eq_u32 s27, 4
    s_cselect_b32 s30, 0, 0x100000
    s_cselect_b32 s34, 0, 0x20000
L_swr_mid:
    s_lshr_b32 s24, s23, 7
    s_waitcnt vmcnt(4)
    s_barrier
    buffer_load_dwordx4 v[96:99], v1, s[28:31], s23 offen offset:0 nt
    buffer_load_dwordx4 v[100:103], v1, s[28:31], s23 offen offset:256 nt
    s_nop 1
    v_mfma_f32_16x16x32_bf16 v[8:11], a[16:19], v[40:43], v[8:11]
    v_mfma_f32_16x16x32_bf16 v[12:15], a[16:19], v[44:47], v[12:15]
    v_mfma_f32_16x16x32_bf16 v[16:19], a[16:19], v[48:51], v[16:19]
    v_mfma_f32_16x16x32_bf16 v[20:23], a[16:19], v[52:55], v[20:23]
    v_mfma_f32_16x16x32_bf16 v[24:27], a[16:19], v[56:59], v[24:27]
    v_mfma_f32_16x16x32_bf16 v[28:31], a[16:19], v[60:63], v[28:31]
    v_mfma_f32_16x16x32_bf16 v[32:35], a[16:19], v[64:67], v[32:35]
    v_mfma_f32_16x16x32_bf16 v[36:39], a[16:19], v[68:71], v[36:39]
    buffer_load_dwordx4 a[16:19], v2, s[32:35], s24 offen sc0
    v_perm_b32 v40, v132, v128, s20
    v_perm_b32 v44, v132, v128, s21
    v_perm_b32 v48, v133, v129, s20
    v_perm_b32 v52, v133, v129, s21
    v_perm_b32 v56, v134, v130, s20
    v_perm_b32 v60, v134, v130, s21
    v_perm_b32 v64, v135, v131, s20
    v_perm_b32 v68, v135, v131, s21
    s_waitcnt vmcnt(5)
    s_barrier
    buffer_load_dwordx4 v[104:107], v1, s[28:31], s23 offen offset:512 nt
    buffer_load_dwordx4 v[108:111], v1, s[28:31], s23 offen offset:768 nt
    v_perm_b32 v41, v140, v136, s20
    v_perm_b32 v45, v140, v136, s21
    v_perm_b32 v49, v141, v137, s20
    v_perm_b32 v53, v141, v137, s21
    v_perm_b32 v57, v142, v138, s20
    v_perm_b32 v61, v142, v138, s21
    v_perm_b32 v65, v143, v139, s20
    v_perm_b32 v69, v143, v139, s21
    s_waitcnt vmcnt(5)
    s_barrier
    buffer_load_dwordx4 v[112:115], v1, s[28:31], s23 offen offset:1024 nt
    buffer_load_dwordx4 v[116:119], v1, s[28:31], s23 offen offset:1280 nt
    s_waitcnt lgkmcnt(0)
    s_cmp_eq_u32 s57, s80
    s_cbranch_scc1 L_rp_mid
L_rpr_mid:
    s_cmp_eq_u32 s57, s64
    s_cbranch_scc1 L_ev_mid
L_evr_mid:
    s_sub_u32 s54, s74, s72
    s_lshl_b32 s54, s54, 6
    s_sub_u32 s54, s54, s66
    s_add_u32 s66, s66, s67
    s_add_u32 s57, s57, 1
    s_cmp_gt_i32 s54, s76
    s_cselect_b32 s65, 1, 0
    s_cmp_lt_i32 s54, s77
    s_cselect_b32 s65, 2, s65
    s_cmp_eq_u32 s57, 63
    s_cselect_b32 s65, 3, s65
    v_perm_b32 v42, v148, v144, s20
    v_perm_b32 v46, v148, v144, s21
    v_perm_b32 v50, v149, v145, s20
    v_perm_b32 v54, v149, v145, s21
    v_perm_b32 v58, v150, v146, s20
    v_perm_b32 v62, v150, v146, s21
    v_perm_b32 v66, v151, v147, s20
    v_perm_b32 v70, v151, v147, s21
    s_waitcnt vmcnt(5)
    s_barrier
    buffer_load_dwordx4 v[120:123], v1, s[28:31], s23 offen offset:1536 nt
    buffer_load_dwordx4 v[124:127], v1, s[28:31], s23 offen offset:1792 nt
    v_perm_b32 v43, v156, v152, s20
    v_perm_b32 v47, v156, v152, s21
    v_perm_b32 v51, v157, v153, s20
    v_perm_b32 v55, v157, v153, s21
    v_perm_b32 v59, v158, v154, s20
    v_perm_b32 v63, v158, v154, s21
    v_perm_b32 v67, v159, v155, s20
    v_perm_b32 v71, v159, v155, s21
    s_sub_u32 s25, s25, 1
    s_cmp_eq_u32 s25, 0
    s_cbranch_scc1 L_matend
    s_branch L_dispatch
L_body_hi:
    s_or_b32 s56, s56, 0x7f00
    s_add_u32 s56, s56, 0x8000
    s_andn2_b32 s56, s56, 0x7f00
    s_xor_b32 s23, s56, s79
    s_lshr_b32 s24, s23, 7
    s_waitcnt vmcnt(7)
    s_barrier
    buffer_load_dwordx4 v[128:131], v1, s[28:31], s23 offen offset:0 nt
    buffer_load_dwordx4 v[132:135], v1, s[28:31], s23 offen offset:256 nt
    s_nop 1
    v_mfma_f32_16x16x32_bf16 v[8:11], a[20:23], v[40:43], v[8:11]
    v_mfma_f32_16x16x32_bf16 v[12:15], a[20:23], v[44:47], v[12:15]
    v_mfma_f32_16x16x32_bf16 v[16:19], a[20:23], v[48:51], v[16:19]
    v_mfma_f32_16x16x32_bf16 v[20:23], a[20:23], v[52:55], v[20:23]
    v_mfma_f32_16x16x32_bf16 v[24:27], a[20:23], v[56:59], v[24:27]
    v_mfma_f32_16x16x32_bf16 v[28:31], a[20:23], v[60:63], v[28:31]
    v_mfma_f32_16x16x32_bf16 v[32:35], a[20:23], v[64:67], v[32:35]
    v_mfma_f32_16x16x32_bf16 v[36:39], a[20:23], v[68:71], v[36:39]
    buffer_load_dwordx4 a[20:23], v2, s[32:35], s24 offen sc0
    v_perm_b32 v40, v100, v96, s20
    v_perm_b32 v44, v100, v96, s21
    v_perm_b32 v48, v101, v97, s20
    v_perm_b32 v52, v101, v97, s21
    v_perm_b32 v56, v102, v98, s20
    v_perm_b32 v60, v102, v98, s21
    v_perm_b32 v64, v103, v99, s20
    v_perm_b32 v68, v103, v99, s21
    s_waitcnt vmcnt(7)
    s_barrier
    buffer_load_dwordx4 v[136:139], v1, s[28:31], s23 offen offset:512 nt
    buffer_load_dwordx4 v[140:143], v1, s[28:31], s23 offen offset:768 nt
    v_perm_b32 v41, v108, v104, s20
    v_perm_b32 v45, v108, v104, s21
    v_perm_b32 v49, v109, v105, s20
    v_perm_b32 v53, v109, v105, s21
    v_perm_b32 v57, v110, v106, s20
    v_perm_b32 v61, v110, v106, s21
    v_perm_b32 v65, v111, v107, s20
    v_perm_b32 v69, v111, v107, s21
    s_waitcnt vmcnt(7)
    s_barrier
    buffer_load_dwordx4 v[144:147], v1, s[28:31], s23 offen offset:1024 nt
    buffer_load_dwordx4 v[148:151], v1, s[28:31], s23 offen offset:1280 nt
    v_perm_b32 v42, v116, v112, s20
    v_perm_b32 v46, v116, v112, s21
    v_perm_b32 v50, v117, v113, s20
    v_perm_b32 v54, v117, v113, s21
    v_perm_b32 v58, v118, v114, s20
    v_perm_b32 v62, v118, v114, s21
    v_perm_b32 v66, v119, v115, s20
    v_perm_b32 v70, v119, v115, s21
    s_waitcnt vmcnt(7)
    s_barrier
    buffer_load_dwordx4 v[152:155], v1, s[28:31], s23 offen offset:1536 nt
    buffer_load_dwordx4 v[156:159], v1, s[28:31], s23 offen offset:1792 nt
    s_memrealtime s[74:75]
    v_perm_b32 v43, v124, v120, s20
    v_perm_b32 v47, v124, v120, s21
    v_perm_b32 v51, v125, v121, s20
    v_perm_b32 v55, v125, v121, s21
    v_perm_b32 v59, v126, v122, s20
    v_perm_b32 v63, v126, v122, s21
    v_perm_b32 v67, v127, v123, s20
    v_perm_b32 v71, v127, v123, s21
    s_or_b32 s56, s56, 0x7f00
    s_add_u32 s56, s56, 0x8000
    s_andn2_b32 s56, s56, 0x7f00
    s_xor_b32 s23, s56, s79
    s_cmp_eq_u32 s25, 1
    s_cbranch_scc0 L_swr_hi
    s_mov_b32 s23, s79
    s_mov_b32 s56, 0
    s_add_u32 s52, s28, 0x100000
    s_addc_u32 s53, s29, 0
    s_mov_b32 s28, s36
    s_mov_b32 s29, s37
    s_mov_b32 s36, s52
    s_mov_b32 s37, s53
    s_mov_b32 s52, s32
    s_mov_b32 s53, s33
    s_mov_b32 s32, s38
    s_mov_b32 s33, s39
    s_mov_b32 s38, s52
    s_mov_b32 s39, s53
    s_add_u32 s27, s27, 1
    s_cmp_eq_u32 s27, 4
    s_cselect_b32 s30, 0, 0x100000
    s_cselect_b32 s34, 0, 0x20000
L_swr_hi:
    s_lshr_b32 s24, s23, 7
    s_waitcnt vmcnt(7)
    s_barrier
    buffer_load_dwordx4 v[96:99], v1, s[28:31], s23 offen offset:0 nt
    buffer_load_dwordx4 v[100:103], v1, s[28:31], s23 offen offset:256 nt
    s_nop 1
    v_mfma_f32_16x16x32_bf16 v[8:11], a[16:19], v[40:43], v[8:11]
    v_mfma_f32_16x16x32_bf16 v[12:15], a[16:19], v[44:47], v[12:15]
    v_mfma_f32_16x16x32_bf16 v[16:19], a[16:19], v[48:51], v[16:19]
    v_mfma_f32_16x16x32_bf16 v[20:23], a[16:19], v[52:55], v[20:23]
    v_mfma_f32_16x16x32_bf16 v[24:27], a[16:19], v[56:59], v[24:27]
    v_mfma_f32_16x16x32_bf16 v[28:31], a[16:19], v[60:63], v[28:31]
    v_mfma_f32_16x16x32_bf16 v[32:35], a[16:19], v[64:67], v[32:35]
    v_mfma_f32_16x16x32_bf16 v[36:39], a[16:19], v[68:71], v[36:39]
    buffer_load_dwordx4 a[16:19], v2, s[32:35], s24 offen sc0
    v_perm_b32 v40, v132, v128, s20
    v_perm_b32 v44, v132, v128, s21
    v_perm_b32 v48, v133, v129, s20
    v_perm_b32 v52, v133, v129, s21
    v_perm_b32 v56, v134, v130, s20
    v_perm_b32 v60, v134, v130, s21
    v_perm_b32 v64, v135, v131, s20
    v_perm_b32 v68, v135, v131, s21
    s_waitcnt vmcnt(7)
    s_barrier
    buffer_load_dwordx4 v[104:107], v1, s[28:31], s23 offen offset:512 nt
    buffer_load_dwordx4 v[108:111], v1, s[28:31], s23 offen offset:768 nt
    v_perm_b32 v41, v140, v136, s20
    v_perm_b32 v45, v140, v136, s21
    v_perm_b32 v49, v141, v137, s20
    v_perm_b32 v53, v141, v137, s21
    v_perm_b32 v57, v142, v138, s20
    v_perm_b32 v61, v142, v138, s21
    v_perm_b32 v65, v143, v139, s20
    v_perm_b32 v69, v143, v139, s21
    s_waitcnt vmcnt(7)
    s_barrier
    buffer_load_dwordx4 v[112:115], v1, s[28:31], s23 offen offset:1024 nt
    buffer_load_dwordx4 v[116:119], v1, s[28:31], s23 offen offset:1280 nt
    s_waitcnt lgkmcnt(0)
    s_cmp_eq_u32 s57, s80
    s_cbranch_scc1 L_rp_hi
L_rpr_hi:
    s_cmp_eq_u32 s57, s64
    s_cbranch_scc1 L_ev_hi
L_evr_hi:
    s_sub_u32 s54, s74, s72
    s_lshl_b32 s54, s54, 6
    s_sub_u32 s54, s54, s66
    s_add_u32 s66, s66, s67
    s_add_u32 s57, s57, 1
    s_cmp_gt_i32 s54, s76
    s_cselect_b32 s65, 1, 0
    s_cmp_lt_i32 s54, s77
    s_cselect_b32 s65, 2, s65
    s_cmp_eq_u32 s57, 63
    s_cselect_b32 s65, 3, s65
    v_perm_b32 v42, v148, v144, s20
    v_perm_b32 v46, v148, v144, s21
    v_perm_b32 v50, v149, v145, s20
    v_perm_b32 v54, v149, v145, s21
    v_perm_b32 v58, v150, v146, s20
    v_perm_b32 v62, v150, v146, s21
    v_perm_b32 v66, v151, v147, s20
    v_perm_b32 v70, v151, v147, s21
    s_waitcnt vmcnt(7)
    s_barrier
    buffer_load_dwordx4 v[120:123], v1, s[28:31], s23 offen offset:1536 nt
    buffer_load_dwordx4 v[124:127], v1, s[28:31], s23 offen offset:1792 nt
    v_perm_b32 v43, v156, v152, s20
    v_perm_b32 v47, v156, v152, s21
    v_perm_b32 v51, v157, v153, s20
    v_perm_b32 v55, v157, v153, s21
    v_perm_b32 v59, v158, v154, s20
    v_perm_b32 v63, v158, v154, s21
    v_perm_b32 v67, v159, v155, s20
    v_perm_b32 v71, v159, v155, s21
    s_sub_u32 s25, s25, 1
    s_cmp_eq_u32 s25, 0
    s_cbranch_scc1 L_matend
    s_branch L_dispatch
L_body_lo:
    s_or_b32 s56, s56, 0x7f00
    s_add_u32 s56, s56, 0x8000
    s_andn2_b32 s56, s56, 0x7f00
    s_xor_b32 s23, s56, s79
    s_lshr_b32 s24, s23, 7
    s_waitcnt vmcnt(4)
    s_barrier
    buffer_load_dwordx4 v[128:131], v1, s[28:31], s23 offen offset:0 nt
    s_waitcnt vmcnt(4)
    buffer_load_dwordx4 v[132:135], v1, s[28:31], s23 offen offset:256 nt
    s_nop 1
    v_mfma_f32_16x16x32_bf16 v[8:11], a[20:23], v[40:43], v[8:11]
    v_mfma_f32_16x16x32_bf16 v[12:15], a[20:23], v[44:47], v[12:15]
    v_mfma_f32_16x16x32_bf16 v[16:19], a[20:23], v[48:51], v[16:19]
    v_mfma_f32_16x16x32_bf16 v[20:23], a[20:23], v[52:55], v[20:23]
    v_mfma_f32_16x16x32_bf16 v[24:27], a[20:23], v[56:59], v[24:27]
    v_mfma_f32_16x16x32_bf16 v[28:31], a[20:23], v[60:63], v[28:31]
    v_mfma_f32_16x16x32_bf16 v[32:35], a[20:23], v[64:67], v[32:35]
    v_mfma_f32_16x16x32_bf16 v[36:39], a[20:23], v[68:71], v[36:39]
    buffer_load_dwordx4 a[20:23], v2, s[32:35], s24 offen sc0
    v_perm_b32 v40, v100, v96, s20
    v_perm_b32 v44, v100, v96, s21
    v_perm_b32 v48, v101, v97, s20
    v_perm_b32 v52, v101, v97, s21
    v_perm_b32 v56, v102, v98, s20
    v_perm_b32 v60, v102, v98, s21
    v_perm_b32 v64, v103, v99, s20
    v_perm_b32 v68, v103, v99, s21
    s_waitcnt vmcnt(5)
    s_barrier
    buffer_load_dwordx4 v[136:139], v1, s[28:31], s23 offen offset:512 nt
    s_waitcnt vmcnt(5)
    buffer_load_dwordx4 v[140:143], v1, s[28:31], s23 offen offset:768 nt
    v_perm_b32 v41, v108, v104, s20
    v_perm_b32 v45, v108, v104, s21
    v_perm_b32 v49, v109, v105, s20
    v_perm_b32 v53, v109, v105, s21
    v_perm_b32 v57, v110, v106, s20
    v_perm_b32 v61, v110, v106, s21
    v_perm_b32 v65, v111, v107, s20
    v_perm_b32 v69, v111, v107, s21
    s_waitcnt vmcnt(5)
    s_barrier
    buffer_load_dwordx4 v[144:147], v1, s[28:31], s23 offen offset:1024 nt
    s_waitcnt vmcnt(5)
    buffer_load_dwordx4 v[148:151], v1, s[28:31], s23 offen offset:1280 nt
    v_perm_b32 v42, v116, v112, s20
    v_perm_b32 v46, v116, v112, s21
    v_perm_b32 v50, v117, v113, s20
    v_perm_b32 v54, v117, v113, s21
    v_perm_b32 v58, v118, v114, s20
    v_perm_b32 v62, v118, v114, s21
    v_perm_b32 v66, v119, v115, s20
    v_perm_b32 v70, v119, v115, s21
    s_waitcnt vmcnt(5)
    s_barrier
    buffer_load_dwordx4 v[152:155], v1, s[28:31], s23 offen offset:1536 nt
    s_waitcnt vmcnt(4)
    buffer_load_dwordx4 v[156:159], v1, s[28:31], s23 offen offset:1792 nt
    s_memrealtime s[74:75]
    v_perm_b32 v43, v124, v120, s20
    v_perm_b32 v47, v124, v120, s21
    v_perm_b32 v51, v125, v121, s20
    v_perm_b32 v55, v125, v121, s21
    v_perm_b32 v59, v126, v122, s20
    v_perm_b32 v63, v126, v122, s21
    v_perm_b32 v67, v127, v123, s20
    v_perm_b32 v71, v127, v123, s21
    s_or_b32 s56, s56, 0x7f00
    s_add_u32 s56, s56, 0x8000
    s_andn2_b32 s56, s56, 0x7f00
    s_xor_b32 s23, s56, s79
    s_cmp_eq_u32 s25, 1
    s_cbranch_scc0 L_swr_lo
    s_mov_b32 s23, s79
    s_mov_b32 s56, 0
    s_add_u32 s52, s28, 0x100000
    s_addc_u32 s53, s29, 0
    s_mov_b32 s28, s36
    s_mov_b32 s29, s37
    s_mov_b32 s36, s52
    s_mov_b32 s37, s53
    s_mov_b32 s52, s32
    s_mov_b32 s53, s33
    s_mov_b32 s32, s38
    s_mov_b32 s33, s39
    s_mov_b32 s38, s52
    s_mov_b32 s39, s53
    s_add_u32 s27, s27, 1
    s_cmp_eq_u32 s27, 4
    s_cselect_b32 s30, 0, 0x100000
    s_cselect_b32 s34, 0, 0x20000
L_swr_lo:
    s_lshr_b32 s24, s23, 7
    s_waitcnt vmcnt(4)
    s_barrier
    buffer_load_dwordx4 v[96:99], v1, s[28:31], s23 offen offset:0 nt
    s_waitcnt vmcnt(4)
    buffer_load_dwordx4 v[100:103], v1, s[28:31], s23 offen offset:256 nt
    s_nop 1
    v_mfma_f32_16x16x32_bf16 v[8:11], a[16:19], v[40:43], v[8:11]
    v_mfma_f32_16x16x32_bf16 v[12:15], a[16:19], v[44:47], v[12:15]
    v_mfma_f32_16x16x32_bf16 v[16:19], a[16:19], v[48:51], v[16:19]
    v_mfma_f32_16x16x32_bf16 v[20:23], a[16:19], v[52:55], v[20:23]
    v_mfma_f32_16x16x32_bf16 v[24:27], a[16:19], v[56:59], v[24:27]
    v_mfma_f32_16x16x32_bf16 v[28:31], a[16:19], v[60:63], v[28:31]
    v_mfma_f32_16x16x32_bf16 v[32:35], a[16:19], v[64:67], v[32:35]
    v_mfma_f32_16x16x32_bf16 v[36:39], a[16:19], v[68:71], v[36:39]
    buffer_load_dwordx4 a[16:19], v2, s[32:35], s24 offen sc0
    v_perm_b32 v40, v132, v128, s20
    v_perm_b32 v44, v132, v128, s21
    v_perm_b32 v48, v133, v129, s20
    v_perm_b32 v52, v133, v129, s21
    v_perm_b32 v56, v134, v130, s20
    v_perm_b32 v60, v134, v130, s21
    v_perm_b32 v64, v135, v131, s20
    v_perm_b32 v68, v135, v131, s21
    s_waitcnt vmcnt(5)
    s_barrier
    buffer_load_dwordx4 v[104:107], v1, s[28:31], s23 offen offset:512 nt
    s_waitcnt vmcnt(5)
    buffer_load_dwordx4 v[108:111], v1, s[28:31], s23 offen offset:768 nt
    v_perm_b32 v41, v140, v136, s20
    v_perm_b32 v45, v140, v136, s21
    v_perm_b32 v49, v141, v137, s20
    v_perm_b32 v53, v141, v137, s21
    v_perm_b32 v57, v142, v138, s20
    v_perm_b32 v61, v142, v138, s21
    v_perm_b32 v65, v143, v139, s20
    v_perm_b32 v69, v143, v139, s21
    s_waitcnt vmcnt(5)
    s_barrier
    buffer_load_dwordx4 v[112:115], v1, s[28:31], s23 offen offset:1024 nt
    s_waitcnt vmcnt(5)
    buffer_load_dwordx4 v[116:119], v1, s[28:31], s23 offen offset:1280 nt
    s_waitcnt lgkmcnt(0)
    s_cmp_eq_u32 s57, s80
    s_cbranch_scc1 L_rp_lo
L_rpr_lo:
    s_cmp_eq_u32 s57, s64
    s_cbranch_scc1 L_ev_lo
L_evr_lo:
    s_sub_u32 s54, s74, s72
    s_lshl_b32 s54, s54, 6
    s_sub_u32 s54, s54, s66
    s_add_u32 s66, s66, s67
    s_add_u32 s57, s57, 1
    s_cmp_gt_i32 s54, s76
    s_cselect_b32 s65, 1, 0
    s_cmp_lt_i32 s54, s77
    s_cselect_b32 s65, 2, s65
    s_cmp_eq_u32 s57, 63
    s_cselect_b32 s65, 3, s65
    v_perm_b32 v42, v148, v144, s20
    v_perm_b32 v46, v148, v144, s21
    v_perm_b32 v50, v149, v145, s20
    v_perm_b32 v54, v149, v145, s21
    v_perm_b32 v58, v150, v146, s20
    v_perm_b32 v62, v150, v146, s21
    v_perm_b32 v66, v151, v147, s20
    v_perm_b32 v70, v151, v147, s21
    s_waitcnt vmcnt(5)
    s_barrier
    buffer_load_dwordx4 v[120:123], v1, s[28:31], s23 offen offset:1536 nt
    s_waitcnt vmcnt(4)
    buffer_load_dwordx4 v[124:127], v1, s[28:31], s23 offen offset:1792 nt
    v_perm_b32 v43, v156, v152, s20
    v_perm_b32 v47, v156, v152, s21
    v_perm_b32 v51, v157, v153, s20
    v_perm_b32 v55, v157, v153, s21
    v_perm_b32 v59, v158, v154, s20
    v_perm_b32 v63, v158, v154, s21
    v_perm_b32 v67, v159, v155, s20
    v_perm_b32 v71, v159, v155, s21
    s_sub_u32 s25, s25, 1
    s_cmp_eq_u32 s25, 0
    s_cbranch_scc1 L_matend
    s_branch L_dispatch
L_body_fin:
    v_lshlrev_b32 v6, 3, v0
    ds_read_b64 v[72:73], v6 offset:0
    buffer_store_dwordx4 v[160:163], v5, s[44:47], 0 offen
    s_or_b32 s56, s56, 0x7f00
    s_add_u32 s56, s56, 0x8000
    s_andn2_b32 s56, s56, 0x7f00
    s_xor_b32 s23, s56, s79
    s_andn2_b32 s48, s23, 0x6000
    s_or_b32 s49, s48, 0x2000
    s_or_b32 s50, s48, 0x4000
    s_or_b32 s51, s48, 0x6000
    v_and_b32 v6, 15, v0
    v_lshrrev_b32 v7, 4, v0
    s_lshl_b32 s52, s22, 6
    v_lshlrev_b32 v188, 2, v6
    v_lshl_add_u32 v188, v7, 11, v188
    v_add_u32 v188, s52, v188
    v_lshlrev_b32 v190, 4, v0
    v_add_u32 v190, 70144, v190
    ds_read_b128 v[164:167], v190 offset:0
    ds_read_b128 v[168:171], v190 offset:1024
    ds_read_b128 v[172:175], v190 offset:2048
    ds_read_b128 v[176:179], v190 offset:3072
    s_barrier
    buffer_load_dword v128, v188, s[28:31], s48 offen offset:0 nt
    buffer_load_dword v129, v188, s[28:31], s48 offen offset:256 nt
    buffer_load_dword v130, v188, s[28:31], s48 offen offset:512 nt
    buffer_load_dword v131, v188, s[28:31], s48 offen offset:768 nt
    buffer_load_dword v132, v188, s[28:31], s48 offen offset:1024 nt
    buffer_load_dword v133, v188, s[28:31], s48 offen offset:1280 nt
    buffer_load_dword v134, v188, s[28:31], s48 offen offset:1536 nt
    buffer_load_dword v135, v188, s[28:31], s48 offen offset:1792 nt
    buffer_load_dword v136, v188, s[28:31], s49 offen offset:0 nt
    buffer_load_dword v137, v188, s[28:31], s49 offen offset:256 nt
    buffer_load_dword v138, v188, s[28:31], s49 offen offset:512 nt
    buffer_load_dword v139, v188, s[28:31], s49 offen offset:768 nt
    buffer_load_dword v140, v188, s[28:31], s49 offen offset:1024 nt
    buffer_load_dword v141, v188, s[28:31], s49 offen offset:1280 nt
    buffer_load_dword v142, v188, s[28:31], s49 offen offset:1536 nt
    buffer_load_dword v143, v188, s[28:31], s49 offen offset:1792 nt
    s_nop 1
    v_mfma_f32_16x16x32_bf16 v[8:11], a[20:23], v[40:43], v[8:11]
    v_mfma_f32_16x16x32_bf16 v[12:15], a[20:23], v[44:47], v[12:15]
    v_mfma_f32_16x16x32_bf16 v[16:19], a[20:23], v[48:51], v[16:19]
    v_mfma_f32_16x16x32_bf16 v[20:23], a[20:23], v[52:55], v[20:23]
    v_mfma_f32_16x16x32_bf16 v[24:27], a[20:23], v[56:59], v[24:27]
    v_mfma_f32_16x16x32_bf16 v[28:31], a[20:23], v[60:63], v[28:31]
    v_mfma_f32_16x16x32_bf16 v[32:35], a[20:23], v[64:67], v[32:35]
    v_mfma_f32_16x16x32_bf16 v[36:39], a[20:23], v[68:71], v[36:39]
    v_and_b32 v189, 3, v6
    v_mul_u32_u24 v189, 2176, v189
    v_lshrrev_b32 v6, 2, v6
    v_lshl_add_u32 v6, v7, 4, v6
    v_lshl_add_u32 v189, v6, 4, v189
    s_lshl_b32 s52, s22, 6
    s_add_u32 s52, s52, 35328
    v_add_u32 v189, s52, v189
    v_add_u32 v7, 34816, v3
    s_waitcnt vmcnt(22)
    v_perm_b32 v40, v100, v96, s20
    v_perm_b32 v44, v100, v96, s21
    v_perm_b32 v48, v101, v97, s20
    v_perm_b32 v52, v101, v97, s21
    v_perm_b32 v56, v102, v98, s20
    v_perm_b32 v60, v102, v98, s21
    v_perm_b32 v64, v103, v99, s20
    v_perm_b32 v68, v103, v99, s21
    s_barrier
    buffer_load_dword v144, v188, s[28:31], s50 offen offset:0 nt
    buffer_load_dword v145, v188, s[28:31], s50 offen offset:256 nt
    buffer_load_dword v146, v188, s[28:31], s50 offen offset:512 nt
    buffer_load_dword v147, v188, s[28:31], s50 offen offset:768 nt
    buffer_load_dword v148, v188, s[28:31], s50 offen offset:1024 nt
    buffer_load_dword v149, v188, s[28:31], s50 offen offset:1280 nt
    buffer_load_dword v150, v188, s[28:31], s50 offen offset:1536 nt
    buffer_load_dword v151, v188, s[28:31], s50 offen offset:1792 nt
    s_waitcnt vmcnt(28)
    v_perm_b32 v41, v108, v104, s20
    v_perm_b32 v45, v108, v104, s21
    v_perm_b32 v49, v109, v105, s20
    v_perm_b32 v53, v109, v105, s21
    v_perm_b32 v57, v110, v106, s20
    v_perm_b32 v61, v110, v106, s21
    v_perm_b32 v65, v111, v107, s20
    v_perm_b32 v69, v111, v107, s21
    s_barrier
    buffer_load_dword v152, v188, s[28:31], s51 offen offset:0 nt
    buffer_load_dword v153, v188, s[28:31], s51 offen offset:256 nt
    buffer_load_dword v154, v188, s[28:31], s51 offen offset:512 nt
    buffer_load_dword v155, v188, s[28:31], s51 offen offset:768 nt
    buffer_load_dword v156, v188, s[28:31], s51 offen offset:1024 nt
    buffer_load_dword v157, v188, s[28:31], s51 offen offset:1280 nt
    buffer_load_dword v158, v188, s[28:31], s51 offen offset:1536 nt
    buffer_load_dword v159, v188, s[28:31], s51 offen offset:1792 nt
    s_waitcnt vmcnt(34)
    v_perm_b32 v42, v116, v112, s20
    v_perm_b32 v46, v116, v112, s21
    v_perm_b32 v50, v117, v113, s20
    v_perm_b32 v54, v117, v113, s21
    v_perm_b32 v58, v118, v114, s20
    v_perm_b32 v62, v118, v114, s21
    v_perm_b32 v66, v119, v115, s20
    v_perm_b32 v70, v119, v115, s21
    s_waitcnt vmcnt(32)
    v_perm_b32 v43, v124, v120, s20
    v_perm_b32 v47, v124, v120, s21
    v_perm_b32 v51, v125, v121, s20
    v_perm_b32 v55, v125, v121, s21
    v_perm_b32 v59, v126, v122, s20
    v_perm_b32 v63, v126, v122, s21
    v_perm_b32 v67, v127, v123, s20
    v_perm_b32 v71, v127, v123, s21
    s_nop 1
    v_mfma_f32_16x16x32_bf16 v[8:11], a[16:19], v[40:43], v[8:11]
    v_mfma_f32_16x16x32_bf16 v[12:15], a[16:19], v[44:47], v[12:15]
    v_mfma_f32_16x16x32_bf16 v[16:19], a[16:19], v[48:51], v[16:19]
    v_mfma_f32_16x16x32_bf16 v[20:23], a[16:19], v[52:55], v[20:23]
    v_mfma_f32_16x16x32_bf16 v[24:27], a[16:19], v[56:59], v[24:27]
    v_mfma_f32_16x16x32_bf16 v[28:31], a[16:19], v[60:63], v[28:31]
    v_mfma_f32_16x16x32_bf16 v[32:35], a[16:19], v[64:67], v[32:35]
    v_mfma_f32_16x16x32_bf16 v[36:39], a[16:19], v[68:71], v[36:39]
    s_nop 0
    ds_write_b128 v7, v[8:11] offset:0
    ds_write_b128 v7, v[12:15] offset:1088
    ds_write_b128 v7, v[16:19] offset:2176
    ds_write_b128 v7, v[20:23] offset:3264
    ds_write_b128 v7, v[24:27] offset:4352
    ds_write_b128 v7, v[28:31] offset:5440
    ds_write_b128 v7, v[32:35] offset:6528
    ds_write_b128 v7, v[36:39] offset:7616
    s_waitcnt lgkmcnt(0)
    s_barrier
    ds_read_b128 v[196:199], v189 offset:0
    ds_read_b128 v[200:203], v189 offset:1088
    ds_read_b128 v[204:207], v189 offset:8704
    ds_read_b128 v[208:211], v189 offset:9792
    ds_read_b128 v[212:215], v189 offset:17408
    ds_read_b128 v[216:219], v189 offset:18496
    ds_read_b128 v[220:223], v189 offset:26112
    ds_read_b128 v[224:227], v189 offset:27200
    s_waitcnt vmcnt(24)
    v_perm_b32 v40, v129, v128, s20
    v_perm_b32 v41, v131, v130, s20
    v_perm_b32 v42, v133, v132, s20
    v_perm_b32 v43, v135, v134, s20
    v_perm_b32 v44, v129, v128, s21
    v_perm_b32 v45, v131, v130, s21
    v_perm_b32 v46, v133, v132, s21
    v_perm_b32 v47, v135, v134, s21
    s_nop 1
    v_mfma_f32_16x16x32_bf16 v[180:183], v[164:167], v[40:43], 0
    v_mfma_f32_16x16x32_bf16 v[184:187], v[164:167], v[44:47], 0
    s_waitcnt vmcnt(16)
    v_perm_b32 v48, v137, v136, s20
    v_perm_b32 v49, v139, v138, s20
    v_perm_b32 v50, v141, v140, s20
    v_perm_b32 v51, v143, v142, s20
    v_perm_b32 v52, v137, v136, s21
    v_perm_b32 v53, v139, v138, s21
    v_perm_b32 v54, v141, v140, s21
    v_perm_b32 v55, v143, v142, s21
    s_nop 1
    v_mfma_f32_16x16x32_bf16 v[180:183], v[168:171], v[48:51], v[180:183]
    v_mfma_f32_16x16x32_bf16 v[184:187], v[168:171], v[52:55], v[184:187]
    s_waitcnt lgkmcnt(0)
    v_add_f32 v196, v196, v204
    v_add_f32 v197, v197, v205
    v_add_f32 v198, v198, v206
    v_add_f32 v199, v199, v207
    v_add_f32 v200, v200, v208
    v_add_f32 v201, v201, v209
    v_add_f32 v202, v202, v210
    v_add_f32 v203, v203, v211
    v_add_f32 v212, v212, v220
    v_add_f32 v213, v213, v221
    v_add_f32 v214, v214, v222
    v_add_f32 v215, v215, v223
    v_add_f32 v216, v216, v224
    v_add_f32 v217, v217, v225
    v_add_f32 v218, v218, v226
    v_add_f32 v219, v219, v227
    v_add_f32 v196, v196, v212
    v_add_f32 v197, v197, v213
    v_add_f32 v198, v198, v214
    v_add_f32 v199, v199, v215
    v_add_f32 v200, v200, v216
    v_add_f32 v201, v201, v217
    v_add_f32 v202, v202, v218
    v_add_f32 v203, v203, v219
    v_add_f32 v180, v180, v196
    v_add_f32 v181, v181, v197
    v_add_f32 v182, v182, v198
    v_add_f32 v183, v183, v199
    v_add_f32 v184, v184, v200
    v_add_f32 v185, v185, v201
    v_add_f32 v186, v186, v202
    v_add_f32 v187, v187, v203
    s_waitcnt vmcnt(8)
    v_perm_b32 v56, v145, v144, s20
    v_perm_b32 v57, v147, v146, s20
    v_perm_b32 v58, v149, v148, s20
    v_perm_b32 v59, v151, v150, s20
    v_perm_b32 v60, v145, v144, s21
    v_perm_b32 v61, v147, v146, s21
    v_perm_b32 v62, v149, v148, s21
    v_perm_b32 v63, v151, v150, s21
    s_nop 1
    v_mfma_f32_16x16x32_bf16 v[180:183], v[172:175], v[56:59], v[180:183]
    v_mfma_f32_16x16x32_bf16 v[184:187], v[172:175], v[60:63], v[184:187]
    s_waitcnt vmcnt(0)
    v_perm_b32 v64, v153, v152, s20
    v_perm_b32 v65, v155, v154, s20
    v_perm_b32 v66, v157, v156, s20
    v_perm_b32 v67, v159, v158, s20
    v_perm_b32 v68, v153, v152, s21
    v_perm_b32 v69, v155, v154, s21
    v_perm_b32 v70, v157, v156, s21
    v_perm_b32 v71, v159, v158, s21
    s_nop 1
    v_mfma_f32_16x16x32_bf16 v[180:183], v[176:179], v[64:67], v[180:183]
    v_mfma_f32_16x16x32_bf16 v[184:187], v[176:179], v[68:71], v[184:187]
    s_mov_b32 s50, 0x1000
    s_nop 5
    v_cvt_pk_bf16_f32 v76, v180, v181
    v_cvt_pk_bf16_f32 v77, v182, v183
    v_cvt_pk_bf16_f32 v78, v184, v185
    v_cvt_pk_bf16_f32 v79, v186, v187
    s_nop 1
    v_mfma_f32_16x16x16_bf16 v[196:199], v[76:77], v[72:73], 0
    v_mfma_f32_16x16x16_bf16 v[200:203], v[78:79], v[72:73], 0
    s_nop 7
    v_cvt_pk_bf16_f32 v80, v196, v200
    v_cvt_pk_bf16_f32 v81, v197, v201
    v_cvt_pk_bf16_f32 v82, v198, v202
    v_cvt_pk_bf16_f32 v83, v199, v203
    buffer_store_dwordx4 v[80:83], v5, s[44:47], s50 offen
    s_branch L_fin
L_matend:
    s_and_b32 s48, s26, 1
    s_mul_i32 s49, s48, 34816
    v_add_u32 v6, s49, v3
    s_mov_b32 s63, s26
    s_add_u32 s26, s26, 1
    s_mov_b32 s25, 16
    s_cmp_eq_u32 s48, 1
    s_cbranch_scc1 L_body_ihV
L_body_ihK:
    s_or_b32 s56, s56, 0x7f00
    s_add_u32 s56, s56, 0x8000
    s_andn2_b32 s56, s56, 0x7f00
    s_xor_b32 s23, s56, s79
    s_lshr_b32 s24, s23, 7
    s_waitcnt vmcnt(4)
    s_barrier
    buffer_load_dwordx4 v[128:131], v1, s[28:31], s23 offen offset:0 nt
    buffer_load_dwordx4 v[132:135], v1, s[28:31], s23 offen offset:256 nt
    s_nop 1
    v_mfma_f32_16x16x32_bf16 v[8:11], a[20:23], v[40:43], v[8:11]
    v_mfma_f32_16x16x32_bf16 v[12:15], a[20:23], v[44:47], v[12:15]
    v_mfma_f32_16x16x32_bf16 v[16:19], a[20:23], v[48:51], v[16:19]
    v_mfma_f32_16x16x32_bf16 v[20:23], a[20:23], v[52:55], v[20:23]
    v_mfma_f32_16x16x32_bf16 v[24:27], a[20:23], v[56:59], v[24:27]
    v_mfma_f32_16x16x32_bf16 v[28:31], a[20:23], v[60:63], v[28:31]
    v_mfma_f32_16x16x32_bf16 v[32:35], a[20:23], v[64:67], v[32:35]
    v_mfma_f32_16x16x32_bf16 v[36:39], a[20:23], v[68:71], v[36:39]
    buffer_load_dwordx4 a[20:23], v2, s[32:35], s24 offen sc0
    s_nop 7
    s_nop 3
    ds_write_b128 v6, v[8:11] offset:0
    ds_write_b128 v6, v[12:15] offset:1088
    ds_write_b128 v6, v[16:19] offset:2176
    ds_write_b128 v6, v[20:23] offset:3264
    v_perm_b32 v40, v100, v96, s20
    v_perm_b32 v44, v100, v96, s21
    v_perm_b32 v48, v101, v97, s20
    v_perm_b32 v52, v101, v97, s21
    v_perm_b32 v56, v102, v98, s20
    v_perm_b32 v60, v102, v98, s21
    v_perm_b32 v64, v103, v99, s20
    v_perm_b32 v68, v103, v99, s21
    s_waitcnt vmcnt(5)
    s_barrier
    buffer_load_dwordx4 v[136:139], v1, s[28:31], s23 offen offset:512 nt
    buffer_load_dwordx4 v[140:143], v1, s[28:31], s23 offen offset:768 nt
    ds_write_b128 v6, v[24:27] offset:4352
    ds_write_b128 v6, v[28:31] offset:5440
    ds_write_b128 v6, v[32:35] offset:6528
    ds_write_b128 v6, v[36:39] offset:7616
    v_perm_b32 v41, v108, v104, s20
    v_perm_b32 v45, v108, v104, s21
    v_perm_b32 v49, v109, v105, s20
    v_perm_b32 v53, v109, v105, s21
    v_perm_b32 v57, v110, v106, s20
    v_perm_b32 v61, v110, v106, s21
    v_perm_b32 v65, v111, v107, s20
    v_perm_b32 v69, v111, v107, s21
    s_waitcnt lgkmcnt(0)
    s_barrier
    s_waitcnt vmcnt(5)
    buffer_load_dwordx4 v[144:147], v1, s[28:31], s23 offen offset:1024 nt
    buffer_load_dwordx4 v[148:151], v1, s[28:31], s23 offen offset:1280 nt
    s_cmp_lg_u32 s22, s63
    s_cbranch_scc1 L_ihs2
    v_lshlrev_b32 v6, 4, v0
    ds_read_b128 v[164:167], v6 offset:512
    ds_read_b128 v[168:171], v6 offset:1600
    ds_read_b128 v[172:175], v6 offset:2688
    ds_read_b128 v[176:179], v6 offset:3776
    ds_read_b128 v[180:183], v6 offset:4864
    ds_read_b128 v[184:187], v6 offset:5952
    ds_read_b128 v[188:191], v6 offset:7040
    ds_read_b128 v[192:195], v6 offset:8128
    ds_read_b128 v[196:199], v6 offset:9216
    ds_read_b128 v[200:203], v6 offset:10304
    ds_read_b128 v[204:207], v6 offset:11392
    ds_read_b128 v[208:211], v6 offset:12480
    ds_read_b128 v[212:215], v6 offset:13568
    ds_read_b128 v[216:219], v6 offset:14656
    ds_read_b128 v[220:223], v6 offset:15744
    ds_read_b128 v[224:227], v6 offset:16832
    v_lshrrev_b32 v7, 4, v0
    v_mul_u32_u24 v7, 272, v7
    v_and_b32 v72, 15, v0
    v_lshl_add_u32 v7, v72, 4, v7
    ds_write_b128 v7, a[0:3] offset:35328
    ds_write_b128 v7, a[4:7] offset:36416
    ds_write_b128 v7, a[8:11] offset:37504
    ds_write_b128 v7, a[12:15] offset:38592
L_ihs2:
    v_perm_b32 v42, v116, v112, s20
    v_perm_b32 v46, v116, v112, s21
    v_perm_b32 v50, v117, v113, s20
    v_perm_b32 v54, v117, v113, s21
    v_perm_b32 v58, v118, v114, s20
    v_perm_b32 v62, v118, v114, s21
    v_perm_b32 v66, v119, v115, s20
    v_perm_b32 v70, v119, v115, s21
    s_waitcnt vmcnt(5)
    s_barrier
    buffer_load_dwordx4 v[152:155], v1, s[28:31], s23 offen offset:1536 nt
    buffer_load_dwordx4 v[156:159], v1, s[28:31], s23 offen offset:1792 nt
    s_memrealtime s[74:75]
    s_cmp_lg_u32 s22, s63
    s_cbranch_scc1 L_ihs3
    s_waitcnt lgkmcnt(0)
    v_and_b32 v7, 15, v0
    v_mul_u32_u24 v7, 272, v7
    v_lshrrev_b32 v72, 4, v0
    v_lshl_add_u32 v7, v72, 6, v7
    ds_read_b128 a[0:3], v7 offset:35328
    ds_read_b128 a[4:7], v7 offset:35344
    ds_read_b128 a[8:11], v7 offset:35360
    ds_read_b128 a[12:15], v7 offset:35376
    v_add_f32 v164, v164, v196
    v_add_f32 v165, v165, v197
    v_add_f32 v166, v166, v198
    v_add_f32 v167, v167, v199
    v_add_f32 v168, v168, v200
    v_add_f32 v169, v169, v201
    v_add_f32 v170, v170, v202
    v_add_f32 v171, v171, v203
    v_add_f32 v172, v172, v204
    v_add_f32 v173, v173, v205
    v_add_f32 v174, v174, v206
    v_add_f32 v175, v175, v207
    v_add_f32 v176, v176, v208
    v_add_f32 v177, v177, v209
    v_add_f32 v178, v178, v210
    v_add_f32 v179, v179, v211
    v_add_f32 v180, v180, v212
    v_add_f32 v181, v181, v213
    v_add_f32 v182, v182, v214
    v_add_f32 v183, v183, v215
    v_add_f32 v184, v184, v216
    v_add_f32 v185, v185, v217
    v_add_f32 v186, v186, v218
    v_add_f32 v187, v187, v219
    v_add_f32 v188, v188, v220
    v_add_f32 v189, v189, v221
    v_add_f32 v190, v190, v222
    v_add_f32 v191, v191, v223
    v_add_f32 v192, v192, v224
    v_add_f32 v193, v193, v225
    v_add_f32 v194, v194, v226
    v_add_f32 v195, v195, v227
    ds_read_b128 v[196:199], v6 offset:17920
    ds_read_b128 v[200:203], v6 offset:19008
    ds_read_b128 v[204:207], v6 offset:20096
    ds_read_b128 v[208:211], v6 offset:21184
    ds_read_b128 v[212:215], v6 offset:22272
    ds_read_b128 v[216:219], v6 offset:23360
    ds_read_b128 v[220:223], v6 offset:24448
    ds_read_b128 v[224:227], v6 offset:25536
L_ihs3:
    v_perm_b32 v43, v124, v120, s20
    v_perm_b32 v47, v124, v120, s21
    v_perm_b32 v51, v125, v121, s20
    v_perm_b32 v55, v125, v121, s21
    v_perm_b32 v59, v126, v122, s20
    v_perm_b32 v63, v126, v122, s21
    v_perm_b32 v67, v127, v123, s20
    v_perm_b32 v71, v127, v123, s21
    s_or_b32 s56, s56, 0x7f00
    s_add_u32 s56, s56, 0x8000
    s_andn2_b32 s56, s56, 0x7f00
    s_xor_b32 s23, s56, s79
    s_lshr_b32 s24, s23, 7
    s_waitcnt vmcnt(4)
    s_barrier
    buffer_load_dwordx4 v[96:99], v1, s[28:31], s23 offen offset:0 nt
    buffer_load_dwordx4 v[100:103], v1, s[28:31], s23 offen offset:256 nt
    s_nop 1
    v_mfma_f32_16x16x32_bf16 v[8:11], a[16:19], v[40:43], 0
    v_mfma_f32_16x16x32_bf16 v[12:15], a[16:19], v[44:47], 0
    v_mfma_f32_16x16x32_bf16 v[16:19], a[16:19], v[48:51], 0
    v_mfma_f32_16x16x32_bf16 v[20:23], a[16:19], v[52:55], 0
    v_mfma_f32_16x16x32_bf16 v[24:27], a[16:19], v[56:59], 0
    v_mfma_f32_16x16x32_bf16 v[28:31], a[16:19], v[60:63], 0
    v_mfma_f32_16x16x32_bf16 v[32:35], a[16:19], v[64:67], 0
    v_mfma_f32_16x16x32_bf16 v[36:39], a[16:19], v[68:71], 0
    buffer_load_dwordx4 a[16:19], v2, s[32:35], s24 offen sc0
    s_cmp_lg_u32 s22, s63
    s_cbranch_scc1 L_ihs4
    s_waitcnt lgkmcnt(0)
    v_add_f32 v164, v164, v196
    v_add_f32 v165, v165, v197
    v_add_f32 v166, v166, v198
    v_add_f32 v167, v167, v199
    v_add_f32 v168, v168, v200
    v_add_f32 v169, v169, v201
    v_add_f32 v170, v170, v202
    v_add_f32 v171, v171, v203
    v_add_f32 v172, v172, v204
    v_add_f32 v173, v173, v205
    v_add_f32 v174, v174, v206
    v_add_f32 v175, v175, v207
    v_add_f32 v176, v176, v208
    v_add_f32 v177, v177, v209
    v_add_f32 v178, v178, v210
    v_add_f32 v179, v179, v211
    v_add_f32 v180, v180, v212
    v_add_f32 v181, v181, v213
    v_add_f32 v182, v182, v214
    v_add_f32 v183, v183, v215
    v_add_f32 v184, v184, v216
    v_add_f32 v185, v185, v217
    v_add_f32 v186, v186, v218
    v_add_f32 v187, v187, v219
    v_add_f32 v188, v188, v220
    v_add_f32 v189, v189, v221
    v_add_f32 v190, v190, v222
    v_add_f32 v191, v191, v223
    v_add_f32 v192, v192, v224
    v_add_f32 v193, v193, v225
    v_add_f32 v194, v194, v226
    v_add_f32 v195, v195, v227
    ds_read_b128 v[196:199], v6 offset:26624
    ds_read_b128 v[200:203], v6 offset:27712
    ds_read_b128 v[204:207], v6 offset:28800
    ds_read_b128 v[208:211], v6 offset:29888
    ds_read_b128 v[212:215], v6 offset:30976
    ds_read_b128 v[216:219], v6 offset:32064
    ds_read_b128 v[220:223], v6 offset:33152
    ds_read_b128 v[224:227], v6 offset:34240
L_ihs4:
    v_perm_b32 v40, v132, v128, s20
    v_perm_b32 v44, v132, v128, s21
    v_perm_b32 v48, v133, v129, s20
    v_perm_b32 v52, v133, v129, s21
    v_perm_b32 v56, v134, v130, s20
    v_perm_b32 v60, v134, v130, s21
    v_perm_b32 v64, v135, v131, s20
    v_perm_b32 v68, v135, v131, s21
    s_waitcnt vmcnt(5)
    s_barrier
    buffer_load_dwordx4 v[104:107], v1, s[28:31], s23 offen offset:512 nt
    buffer_load_dwordx4 v[108:111], v1, s[28:31], s23 offen offset:768 nt
    s_cmp_lg_u32 s22, s63
    s_cbranch_scc1 L_ihs5
    s_waitcnt lgkmcnt(0)
    v_add_f32 v164, v164, v196
    v_add_f32 v165, v165, v197
    v_add_f32 v166, v166, v198
    v_add_f32 v167, v167, v199
    v_add_f32 v168, v168, v200
    v_add_f32 v169, v169, v201
    v_add_f32 v170, v170, v202
    v_add_f32 v171, v171, v203
    v_add_f32 v172, v172, v204
    v_add_f32 v173, v173, v205
    v_add_f32 v174, v174, v206
    v_add_f32 v175, v175, v207
    v_add_f32 v176, v176, v208
    v_add_f32 v177, v177, v209
    v_add_f32 v178, v178, v210
    v_add_f32 v179, v179, v211
    v_add_f32 v180, v180, v212
    v_add_f32 v181, v181, v213
    v_add_f32 v182, v182, v214
    v_add_f32 v183, v183, v215
    v_add_f32 v184, v184, v216
    v_add_f32 v185, v185, v217
    v_add_f32 v186, v186, v218
    v_add_f32 v187, v187, v219
    v_add_f32 v188, v188, v220
    v_add_f32 v189, v189, v221
    v_add_f32 v190, v190, v222
    v_add_f32 v191, v191, v223
    v_add_f32 v192, v192, v224
    v_add_f32 v193, v193, v225
    v_add_f32 v194, v194, v226
    v_add_f32 v195, v195, v227
    v_cvt_pk_bf16_f32 v72, v164, v165
    v_cvt_pk_bf16_f32 v73, v166, v167
    v_cvt_pk_bf16_f32 v74, v168, v169
    v_cvt_pk_bf16_f32 v75, v170, v171
    v_cvt_pk_bf16_f32 v76, v172, v173
    v_cvt_pk_bf16_f32 v77, v174, v175
    v_cvt_pk_bf16_f32 v78, v176, v177
    v_cvt_pk_bf16_f32 v79, v178, v179
    v_cvt_pk_bf16_f32 v80, v180, v181
    v_cvt_pk_bf16_f32 v81, v182, v183
    v_cvt_pk_bf16_f32 v82, v184, v185
    v_cvt_pk_bf16_f32 v83, v186, v187
    v_cvt_pk_bf16_f32 v84, v188, v189
    v_cvt_pk_bf16_f32 v85, v190, v191
    v_cvt_pk_bf16_f32 v86, v192, v193
    v_cvt_pk_bf16_f32 v87, v194, v195
    v_and_b32 v6, 15, v0
    v_lshrrev_b32 v7, 4, v0
    v_lshlrev_b32 v7, 2, v7
    v_sub_u32 v6, v6, v7
    v_mov_b32 v88, 0
    v_mov_b32 v89, 0
    v_mov_b32 v90, 0x3f80
    v_mov_b32 v91, 0x3f800000
    v_cmp_eq_u32 vcc, 0, v6
    s_nop 1
    v_cndmask_b32 v88, v88, v90, vcc
    v_cmp_eq_u32 vcc, 1, v6
    s_nop 1
    v_cndmask_b32 v88, v88, v91, vcc
    v_cmp_eq_u32 vcc, 2, v6
    s_nop 1
    v_cndmask_b32 v89, v89, v90, vcc
    v_cmp_eq_u32 vcc, 3, v6
    s_nop 1
    v_cndmask_b32 v89, v89, v91, vcc
    s_nop 1
    v_mfma_f32_16x16x16_bf16 v[196:199], v[72:73], v[88:89], 0
    v_mfma_f32_16x16x16_bf16 v[200:203], v[74:75], v[88:89], 0
    v_mfma_f32_16x16x16_bf16 v[204:207], v[76:77], v[88:89], 0
    v_mfma_f32_16x16x16_bf16 v[208:211], v[78:79], v[88:89], 0
    v_mfma_f32_16x16x16_bf16 v[212:215], v[80:81], v[88:89], 0
    v_mfma_f32_16x16x16_bf16 v[216:219], v[82:83], v[88:89], 0
    v_mfma_f32_16x16x16_bf16 v[220:223], v[84:85], v[88:89], 0
    v_mfma_f32_16x16x16_bf16 v[224:227], v[86:87], v[88:89], 0
L_ihs5:
    v_perm_b32 v41, v140, v136, s20
    v_perm_b32 v45, v140, v136, s21
    v_perm_b32 v49, v141, v137, s20
    v_perm_b32 v53, v141, v137, s21
    v_perm_b32 v57, v142, v138, s20
    v_perm_b32 v61, v142, v138, s21
    v_perm_b32 v65, v143, v139, s20
    v_perm_b32 v69, v143, v139, s21
    s_waitcnt vmcnt(5)
    s_barrier
    buffer_load_dwordx4 v[112:115], v1, s[28:31], s23 offen offset:1024 nt
    buffer_load_dwordx4 v[116:119], v1, s[28:31], s23 offen offset:1280 nt
    s_waitcnt lgkmcnt(0)
    s_cmp_eq_u32 s57, s80
    s_cbranch_scc1 L_rp_ihK
L_rpr_ihK:
    s_cmp_eq_u32 s57, s64
    s_cbranch_scc1 L_ev_ihK
L_evr_ihK:
    s_sub_u32 s54, s74, s72
    s_lshl_b32 s54, s54, 6
    s_sub_u32 s54, s54, s66
    s_add_u32 s66, s66, s67
    s_add_u32 s57, s57, 1
    s_cmp_gt_i32 s54, s76
    s_cselect_b32 s65, 1, 0
    s_cmp_lt_i32 s54, s77
    s_cselect_b32 s65, 2, s65
    s_cmp_eq_u32 s57, 63
    s_cselect_b32 s65, 3, s65
    s_cmp_lg_u32 s22, s63
    s_cbranch_scc1 L_ihs6
    s_nop 7
    v_cvt_pk_bf16_f32 v164, v196, v200
    v_cvt_pk_bf16_f32 v165, v204, v208
    v_cvt_pk_bf16_f32 v166, v212, v216
    v_cvt_pk_bf16_f32 v167, v220, v224
    v_cvt_pk_bf16_f32 v168, v197, v201
    v_cvt_pk_bf16_f32 v169, v205, v209
    v_cvt_pk_bf16_f32 v170, v213, v217
    v_cvt_pk_bf16_f32 v171, v221, v225
    v_cvt_pk_bf16_f32 v172, v198, v202
    v_cvt_pk_bf16_f32 v173, v206, v210
    v_cvt_pk_bf16_f32 v174, v214, v218
    v_cvt_pk_bf16_f32 v175, v222, v226
    v_cvt_pk_bf16_f32 v176, v199, v203
    v_cvt_pk_bf16_f32 v177, v207, v211
    v_cvt_pk_bf16_f32 v178, v215, v219
    v_cvt_pk_bf16_f32 v179, v223, v227
    s_nop 1
    v_mfma_f32_16x16x32_bf16 v[180:183], v[164:167], a[0:3], 0
    v_mfma_f32_16x16x32_bf16 v[180:183], v[168:171], a[4:7], v[180:183]
    v_mfma_f32_16x16x32_bf16 v[180:183], v[172:175], a[8:11], v[180:183]
    v_mfma_f32_16x16x32_bf16 v[180:183], v[176:179], a[12:15], v[180:183]
L_ihs6:
    v_perm_b32 v42, v148, v144, s20
    v_perm_b32 v46, v148, v144, s21
    v_perm_b32 v50, v149, v145, s20
    v_perm_b32 v54, v149, v145, s21
    v_perm_b32 v58, v150, v146, s20
    v_perm_b32 v62, v150, v146, s21
    v_perm_b32 v66, v151, v147, s20
    v_perm_b32 v70, v151, v147, s21
    s_waitcnt vmcnt(5)
    s_barrier
    buffer_load_dwordx4 v[120:123], v1, s[28:31], s23 offen offset:1536 nt
    buffer_load_dwordx4 v[124:127], v1, s[28:31], s23 offen offset:1792 nt
    s_cmp_lg_u32 s22, s63
    s_cbranch_scc1 L_ihs7
    s_mov_b32 s50, 0x3db504f3
    s_mov_b32 s51, 0x3fb8aa3b
    s_nop 7
    v_cvt_pk_bf16_f32 v184, v180, v181
    v_cvt_pk_bf16_f32 v185, v182, v183
    v_lshlrev_b32 v180, 16, v184
    v_and_b32 v181, 0xffff0000, v184
    v_lshlrev_b32 v182, 16, v185
    v_and_b32 v183, 0xffff0000, v185
    v_mul_f32 v180, s50, v180
    v_mul_f32 v181, s50, v181
    v_mul_f32 v182, s50, v182
    v_mul_f32 v183, s50, v183
    v_cvt_pk_bf16_f32 v184, v180, v181
    v_cvt_pk_bf16_f32 v185, v182, v183
    v_lshlrev_b32 v180, 16, v184
    v_and_b32 v181, 0xffff0000, v184
    v_lshlrev_b32 v182, 16, v185
    v_and_b32 v183, 0xffff0000, v185
    v_max_f32 v186, v180, v181
    v_max3_f32 v186, v182, v183, v186
    v_mov_b32 v187, v186
    s_nop 1
    v_permlane32_swap_b32 v186, v187
    s_nop 1
    v_max_f32 v186, v186, v187
    v_mov_b32 v187, v186
    s_nop 1
    v_permlane16_swap_b32 v186, v187
    s_nop 1
    v_max_f32 v186, v186, v187
    v_sub_f32 v180, v180, v186
    v_sub_f32 v181, v181, v186
    v_sub_f32 v182, v182, v186
    v_sub_f32 v183, v183, v186
    v_mul_f32 v180, s51, v180
    v_mul_f32 v181, s51, v181
    v_mul_f32 v182, s51, v182
    v_mul_f32 v183, s51, v183
    v_exp_f32 v180, v180
    v_exp_f32 v181, v181
    v_exp_f32 v182, v182
    v_exp_f32 v183, v183
    s_nop 0
    v_add_f32 v186, v180, v181
    v_add_f32 v187, v182, v183
    v_add_f32 v186, v186, v187
    v_mov_b32 v187, v186
    s_nop 1
    v_permlane32_swap_b32 v186, v187
    s_nop 1
    v_add_f32 v186, v186, v187
    v_mov_b32 v187, v186
    s_nop 1
    v_permlane16_swap_b32 v186, v187
    s_nop 1
    v_add_f32 v186, v186, v187
    v_rcp_f32 v186, v186
    s_nop 0
    v_mul_f32 v180, v180, v186
    v_mul_f32 v181, v181, v186
    v_mul_f32 v182, v182, v186
    v_mul_f32 v183, v183, v186
    v_cvt_pk_bf16_f32 v184, v180, v181
    v_cvt_pk_bf16_f32 v185, v182, v183
    v_lshlrev_b32 v6, 3, v0
    ds_write_b64 v6, v[184:185] offset:0
L_ihs7:
    v_perm_b32 v43, v156, v152, s20
    v_perm_b32 v47, v156, v152, s21
    v_perm_b32 v51, v157, v153, s20
    v_perm_b32 v55, v157, v153, s21
    v_perm_b32 v59, v158, v154, s20
    v_perm_b32 v63, v158, v154, s21
    v_perm_b32 v67, v159, v155, s20
    v_perm_b32 v71, v159, v155, s21
    s_sub_u32 s25, s25, 1
    s_branch L_dispatch
L_body_ihV:
    v_lshlrev_b32 v7, 4, v0
    s_lshl_b32 s49, s22, 10
    s_add_u32 s49, s49, 70144
    v_add_u32 v7, s49, v7
    ds_write_b128 v7, a[20:23]
    s_or_b32 s56, s56, 0x7f00
    s_add_u32 s56, s56, 0x8000
    s_andn2_b32 s56, s56, 0x7f00
    s_xor_b32 s23, s56, s79
    s_lshr_b32 s24, s23, 7
    s_waitcnt vmcnt(4)
    s_barrier
    buffer_load_dwordx4 v[128:131], v1, s[28:31], s23 offen offset:0 nt
    buffer_load_dwordx4 v[132:135], v1, s[28:31], s23 offen offset:256 nt
    s_nop 1
    v_mfma_f32_16x16x32_bf16 v[8:11], a[20:23], v[40:43], v[8:11]
    v_mfma_f32_16x16x32_bf16 v[12:15], a[20:23], v[44:47], v[12:15]
    v_mfma_f32_16x16x32_bf16 v[16:19], a[20:23], v[48:51], v[16:19]
    v_mfma_f32_16x16x32_bf16 v[20:23], a[20:23], v[52:55], v[20:23]
    v_mfma_f32_16x16x32_bf16 v[24:27], a[20:23], v[56:59], v[24:27]
    v_mfma_f32_16x16x32_bf16 v[28:31], a[20:23], v[60:63], v[28:31]
    v_mfma_f32_16x16x32_bf16 v[32:35], a[20:23], v[64:67], v[32:35]
    v_mfma_f32_16x16x32_bf16 v[36:39], a[20:23], v[68:71], v[36:39]
    buffer_load_dwordx4 a[20:23], v2, s[32:35], s24 offen sc0
    s_nop 7
    s_nop 3
    ds_write_b128 v6, v[8:11] offset:0
    ds_write_b128 v6, v[12:15] offset:1088
    ds_write_b128 v6, v[16:19] offset:2176
    ds_write_b128 v6, v[20:23] offset:3264
    v_perm_b32 v40, v100, v96, s20
    v_perm_b32 v44, v100, v96, s21
    v_perm_b32 v48, v101, v97, s20
    v_perm_b32 v52, v101, v97, s21
    v_perm_b32 v56, v102, v98, s20
    v_perm_b32 v60, v102, v98, s21
    v_perm_b32 v64, v103, v99, s20
    v_perm_b32 v68, v103, v99, s21
    s_waitcnt vmcnt(5)
    s_barrier
    buffer_load_dwordx4 v[136:139], v1, s[28:31], s23 offen offset:512 nt
    buffer_load_dwordx4 v[140:143], v1, s[28:31], s23 offen offset:768 nt
    ds_write_b128 v6, v[24:27] offset:4352
    ds_write_b128 v6, v[28:31] offset:5440
    ds_write_b128 v6, v[32:35] offset:6528
    ds_write_b128 v6, v[36:39] offset:7616
    v_perm_b32 v41, v108, v104, s20
    v_perm_b32 v45, v108, v104, s21
    v_perm_b32 v49, v109, v105, s20
    v_perm_b32 v53, v109, v105, s21
    v_perm_b32 v57, v110, v106, s20
    v_perm_b32 v61, v110, v106, s21
    v_perm_b32 v65, v111, v107, s20
    v_perm_b32 v69, v111, v107, s21
    s_waitcnt lgkmcnt(0)
    s_barrier
    s_waitcnt vmcnt(5)
    buffer_load_dwordx4 v[144:147], v1, s[28:31], s23 offen offset:1024 nt
    buffer_load_dwordx4 v[148:151], v1, s[28:31], s23 offen offset:1280 nt
    v_lshlrev_b32 v6, 3, v0
    ds_read_b64 v[72:73], v6 offset:0
    ds_read_b128 v[196:199], v4 offset:0
    ds_read_b128 v[200:203], v4 offset:4352
    ds_read_b128 v[204:207], v4 offset:8704
    ds_read_b128 v[208:211], v4 offset:13056
    ds_read_b128 v[212:215], v4 offset:17408
    ds_read_b128 v[216:219], v4 offset:21760
    ds_read_b128 v[220:223], v4 offset:26112
    ds_read_b128 v[224:227], v4 offset:30464
    v_perm_b32 v42, v116, v112, s20
    v_perm_b32 v46, v116, v112, s21
    v_perm_b32 v50, v117, v113, s20
    v_perm_b32 v54, v117, v113, s21
    v_perm_b32 v58, v118, v114, s20
    v_perm_b32 v62, v118, v114, s21
    v_perm_b32 v66, v119, v115, s20
    v_perm_b32 v70, v119, v115, s21
    s_waitcnt vmcnt(5)
    s_barrier
    buffer_load_dwordx4 v[152:155], v1, s[28:31], s23 offen offset:1536 nt
    buffer_load_dwordx4 v[156:159], v1, s[28:31], s23 offen offset:1792 nt
    s_memrealtime s[74:75]
    s_waitcnt lgkmcnt(0)
    v_add_f32 v196, v196, v204
    v_add_f32 v197, v197, v205
    v_add_f32 v198, v198, v206
    v_add_f32 v199, v199, v207
    v_add_f32 v200, v200, v208
    v_add_f32 v201, v201, v209
    v_add_f32 v202, v202, v210
    v_add_f32 v203, v203, v211
    v_add_f32 v212, v212, v220
    v_add_f32 v213, v213, v221
    v_add_f32 v214, v214, v222
    v_add_f32 v215, v215, v223
    v_add_f32 v216, v216, v224
    v_add_f32 v217, v217, v225
    v_add_f32 v218, v218, v226
    v_add_f32 v219, v219, v227
    v_add_f32 v196, v196, v212
    v_add_f32 v197, v197, v213
    v_add_f32 v198, v198, v214
    v_add_f32 v199, v199, v215
    v_add_f32 v200, v200, v216
    v_add_f32 v201, v201, v217
    v_add_f32 v202, v202, v218
    v_add_f32 v203, v203, v219
    v_cvt_pk_bf16_f32 v76, v196, v197
    v_cvt_pk_bf16_f32 v77, v198, v199
    v_cvt_pk_bf16_f32 v78, v200, v201
    v_cvt_pk_bf16_f32 v79, v202, v203
    s_nop 1
    v_mfma_f32_16x16x16_bf16 v[212:215], v[76:77], v[72:73], 0
    v_mfma_f32_16x16x16_bf16 v[216:219], v[78:79], v[72:73], 0
    v_perm_b32 v43, v124, v120, s20
    v_perm_b32 v47, v124, v120, s21
    v_perm_b32 v51, v125, v121, s20
    v_perm_b32 v55, v125, v121, s21
    v_perm_b32 v59, v126, v122, s20
    v_perm_b32 v63, v126, v122, s21
    v_perm_b32 v67, v127, v123, s20
    v_perm_b32 v71, v127, v123, s21
    s_or_b32 s56, s56, 0x7f00
    s_add_u32 s56, s56, 0x8000
    s_andn2_b32 s56, s56, 0x7f00
    s_xor_b32 s23, s56, s79
    s_lshr_b32 s24, s23, 7
    s_waitcnt vmcnt(4)
    s_barrier
    buffer_load_dwordx4 v[96:99], v1, s[28:31], s23 offen offset:0 nt
    buffer_load_dwordx4 v[100:103], v1, s[28:31], s23 offen offset:256 nt
    s_nop 1
    v_mfma_f32_16x16x32_bf16 v[8:11], a[16:19], v[40:43], 0
    v_mfma_f32_16x16x32_bf16 v[12:15], a[16:19], v[44:47], 0
    v_mfma_f32_16x16x32_bf16 v[16:19], a[16:19], v[48:51], 0
    v_mfma_f32_16x16x32_bf16 v[20:23], a[16:19], v[52:55], 0
    v_mfma_f32_16x16x32_bf16 v[24:27], a[16:19], v[56:59], 0
    v_mfma_f32_16x16x32_bf16 v[28:31], a[16:19], v[60:63], 0
    v_mfma_f32_16x16x32_bf16 v[32:35], a[16:19], v[64:67], 0
    v_mfma_f32_16x16x32_bf16 v[36:39], a[16:19], v[68:71], 0
    buffer_load_dwordx4 a[16:19], v2, s[32:35], s24 offen sc0
    s_nop 7
    v_cvt_pk_bf16_f32 v160, v212, v213
    v_cvt_pk_bf16_f32 v161, v214, v215
    v_cvt_pk_bf16_f32 v162, v216, v217
    v_cvt_pk_bf16_f32 v163, v218, v219
    v_perm_b32 v40, v132, v128, s20
    v_perm_b32 v44, v132, v128, s21
    v_perm_b32 v48, v133, v129, s20
    v_perm_b32 v52, v133, v129, s21
    v_perm_b32 v56, v134, v130, s20
    v_perm_b32 v60, v134, v130, s21
    v_perm_b32 v64, v135, v131, s20
    v_perm_b32 v68, v135, v131, s21
    s_waitcnt vmcnt(5)
    s_barrier
    buffer_load_dwordx4 v[104:107], v1, s[28:31], s23 offen offset:512 nt
    buffer_load_dwordx4 v[108:111], v1, s[28:31], s23 offen offset:768 nt
    v_perm_b32 v41, v140, v136, s20
    v_perm_b32 v45, v140, v136, s21
    v_perm_b32 v49, v141, v137, s20
    v_perm_b32 v53, v141, v137, s21
    v_perm_b32 v57, v142, v138, s20
    v_perm_b32 v61, v142, v138, s21
    v_perm_b32 v65, v143, v139, s20
    v_perm_b32 v69, v143, v139, s21
    s_waitcnt vmcnt(5)
    s_barrier
    buffer_load_dwordx4 v[112:115], v1, s[28:31], s23 offen offset:1024 nt
    buffer_load_dwordx4 v[116:119], v1, s[28:31], s23 offen offset:1280 nt
    s_waitcnt lgkmcnt(0)
    s_cmp_eq_u32 s57, s80
    s_cbranch_scc1 L_rp_ihV
L_rpr_ihV:
    s_cmp_eq_u32 s57, s64
    s_cbranch_scc1 L_ev_ihV
L_evr_ihV:
    s_sub_u32 s54, s74, s72
    s_lshl_b32 s54, s54, 6
    s_sub_u32 s54, s54, s66
    s_add_u32 s66, s66, s67
    s_add_u32 s57, s57, 1
    s_cmp_gt_i32 s54, s76
    s_cselect_b32 s65, 1, 0
    s_cmp_lt_i32 s54, s77
    s_cselect_b32 s65, 2, s65
    s_cmp_eq_u32 s57, 63
    s_cselect_b32 s65, 3, s65
    v_perm_b32 v42, v148, v144, s20
    v_perm_b32 v46, v148, v144, s21
    v_perm_b32 v50, v149, v145, s20
    v_perm_b32 v54, v149, v145, s21
    v_perm_b32 v58, v150, v146, s20
    v_perm_b32 v62, v150, v146, s21
    v_perm_b32 v66, v151, v147, s20
    v_perm_b32 v70, v151, v147, s21
    s_waitcnt vmcnt(5)
    s_barrier
    buffer_load_dwordx4 v[120:123], v1, s[28:31], s23 offen offset:1536 nt
    buffer_load_dwordx4 v[124:127], v1, s[28:31], s23 offen offset:1792 nt
    v_perm_b32 v43, v156, v152, s20
    v_perm_b32 v47, v156, v152, s21
    v_perm_b32 v51, v157, v153, s20
    v_perm_b32 v55, v157, v153, s21
    v_perm_b32 v59, v158, v154, s20
    v_perm_b32 v63, v158, v154, s21
    v_perm_b32 v67, v159, v155, s20
    v_perm_b32 v71, v159, v155, s21
    s_sub_u32 s25, s25, 1
    s_branch L_dispatch
L_rp_post:
    v_mov_b32 v92, s74
    v_mov_b32 v93, 0x100
    s_mov_b64 exec, 1
    global_atomic_add_x2 v94, v[92:93], s[16:17] sc1
    s_mov_b64 exec, -1
    s_branch L_rpr_post
L_ev_post:
    s_cmp_eq_u32 s64, 1
    s_cbranch_scc1 L_evl0_post
    s_cmp_eq_u32 s64, 2
    s_cbranch_scc1 L_evc0_post
    s_cmp_eq_u32 s64, 13
    s_cbranch_scc1 L_evl1_post
    s_cmp_eq_u32 s64, 14
    s_cbranch_scc1 L_evc1_post
    s_cmp_eq_u32 s64, 29
    s_cbranch_scc1 L_evl2_post
    s_cmp_eq_u32 s64, 30
    s_cbranch_scc1 L_evc2_post
    s_cmp_eq_u32 s64, 45
    s_cbranch_scc1 L_evl3_post
    s_cmp_eq_u32 s64, 46
    s_cbranch_scc1 L_evc3_post
    s_branch L_evr_post
L_evl0_post:
    s_load_dwordx2 s[68:69], s[16:17], 0
    s_mov_b32 s64, 2
    s_branch L_evr_post
L_evc0_post:
    s_mov_b32 s64, 13
    s_lshr_b64 s[68:69], s[68:69], 4
    s_cmp_lg_u32 s69, 256
    s_cbranch_scc1 L_evr_post
    s_sub_u32 s54, s72, s68
    s_lshl_b32 s55, s54, 6
    s_sub_u32 s66, s66, s55
    s_branch L_evr_post
L_evl1_post:
    s_load_dwordx2 s[68:69], s[16:17], 136
    s_load_dwordx2 s[70:71], s[16:17], 128
    s_mov_b32 s64, 14
    s_branch L_evr_post
L_evc1_post:
    s_mov_b32 s64, 29
    s_lshr_b64 s[68:69], s[68:69], 4
    s_lshr_b64 s[70:71], s[70:71], 4
    s_and_b32 s54, s69, s71
    s_sub_u32 s55, s70, s68
    s_mov_b32 s68, s70
    s_mov_b32 s69, s71
    s_cmp_lg_u32 s54, 256
    s_cbranch_scc1 L_evr_post
    s_lshl_b32 s55, s55, 1
    s_mov_b32 s72, s68
    s_lshl_b32 s67, s55, 2
    s_mul_i32 s66, s55, 18
    s_mul_i32 s76, s55, 1
    s_mul_i32 s77, s55, 0
    s_mul_i32 s54, s55, 1
    s_ashr_i32 s54, s54, 6
    s_sub_u32 s67, s67, s54
    s_branch L_evr_post
L_evl2_post:
    s_load_dwordx2 s[70:71], s[16:17], 64
    s_mov_b32 s64, 30
    s_branch L_evr_post
L_evc2_post:
    s_mov_b32 s64, 45
    s_lshr_b64 s[70:71], s[70:71], 4
    s_and_b32 s54, s69, s71
    s_sub_u32 s55, s70, s68
    s_mov_b32 s68, s70
    s_mov_b32 s69, s71
    s_cmp_lg_u32 s54, 256
    s_cbranch_scc1 L_evr_post
    s_mov_b32 s72, s68
    s_lshl_b32 s67, s55, 2
    s_mul_i32 s66, s55, 18
    s_mul_i32 s76, s55, 1
    s_mul_i32 s77, s55, 0
    s_mul_i32 s54, s55, 1
    s_ashr_i32 s54, s54, 6
    s_sub_u32 s67, s67, s54
    s_branch L_evr_post
L_evl3_post:
    s_load_dwordx2 s[70:71], s[16:17], 192
    s_mov_b32 s64, 46
    s_branch L_evr_post
L_evc3_post:
    s_mov_b32 s64, 0x7fffffff
    s_lshr_b64 s[70:71], s[70:71], 4
    s_and_b32 s54, s69, s71
    s_sub_u32 s55, s70, s68
    s_mov_b32 s68, s70
    s_mov_b32 s69, s71
    s_cmp_lg_u32 s54, 256
    s_cbranch_scc1 L_evr_post
    s_mov_b32 s72, s68
    s_lshl_b32 s67, s55, 2
    s_mul_i32 s66, s55, 18
    s_mul_i32 s76, s55, 1
    s_mul_i32 s77, s55, 0
    s_mul_i32 s54, s55, 1
    s_ashr_i32 s54, s54, 6
    s_sub_u32 s67, s67, s54
    s_branch L_evr_post
L_rp_mid:
    v_mov_b32 v92, s74
    v_mov_b32 v93, 0x100
    s_mov_b64 exec, 1
    global_atomic_add_x2 v94, v[92:93], s[16:17] sc1
    s_mov_b64 exec, -1
    s_branch L_rpr_mid
L_ev_mid:
    s_cmp_eq_u32 s64, 1
    s_cbranch_scc1 L_evl0_mid
    s_cmp_eq_u32 s64, 2
    s_cbranch_scc1 L_evc0_mid
    s_cmp_eq_u32 s64, 13
    s_cbranch_scc1 L_evl1_mid
    s_cmp_eq_u32 s64, 14
    s_cbranch_scc1 L_evc1_mid
    s_cmp_eq_u32 s64, 29
    s_cbranch_scc1 L_evl2_mid
    s_cmp_eq_u32 s64, 30
    s_cbranch_scc1 L_evc2_mid
    s_cmp_eq_u32 s64, 45
    s_cbranch_scc1 L_evl3_mid
    s_cmp_eq_u32 s64, 46
    s_cbranch_scc1 L_evc3_mid
    s_branch L_evr_mid
L_evl0_mid:
    s_load_dwordx2 s[68:69], s[16:17], 0
    s_mov_b32 s64, 2
    s_branch L_evr_mid
L_evc0_mid:
    s_mov_b32 s64, 13
    s_lshr_b64 s[68:69], s[68:69], 4
    s_cmp_lg_u32 s69, 256
    s_cbranch_scc1 L_evr_mid
    s_sub_u32 s54, s72, s68
    s_lshl_b32 s55, s54, 6
    s_sub_u32 s66, s66, s55
    s_branch L_evr_mid
L_evl1_mid:
    s_load_dwordx2 s[68:69], s[16:17], 136
    s_load_dwordx2 s[70:71], s[16:17], 128
    s_mov_b32 s64, 14
    s_branch L_evr_mid
L_evc1_mid:
    s_mov_b32 s64, 29
    s_lshr_b64 s[68:69], s[68:69], 4
    s_lshr_b64 s[70:71], s[70:71], 4
    s_and_b32 s54, s69, s71
    s_sub_u32 s55, s70, s68
    s_mov_b32 s68, s70
    s_mov_b32 s69, s71
    s_cmp_lg_u32 s54, 256
    s_cbranch_scc1 L_evr_mid
    s_lshl_b32 s55, s55, 1
    s_mov_b32 s72, s68
    s_lshl_b32 s67, s55, 2
    s_mul_i32 s66, s55, 18
    s_mul_i32 s76, s55, 1
    s_mul_i32 s77, s55, 0
    s_mul_i32 s54, s55, 1
    s_ashr_i32 s54, s54, 6
    s_sub_u32 s67, s67, s54
    s_branch L_evr_mid
L_evl2_mid:
    s_load_dwordx2 s[70:71], s[16:17], 64
    s_mov_b32 s64, 30
    s_branch L_evr_mid
L_evc2_mid:
    s_mov_b32 s64, 45
    s_lshr_b64 s[70:71], s[70:71], 4
    s_and_b32 s54, s69, s71
    s_sub_u32 s55, s70, s68
    s_mov_b32 s68, s70
    s_mov_b32 s69, s71
    s_cmp_lg_u32 s54, 256
    s_cbranch_scc1 L_evr_mid
    s_mov_b32 s72, s68
    s_lshl_b32 s67, s55, 2
    s_mul_i32 s66, s55, 18
    s_mul_i32 s76, s55, 1
    s_mul_i32 s77, s55, 0
    s_mul_i32 s54, s55, 1
    s_ashr_i32 s54, s54, 6
    s_sub_u32 s67, s67, s54
    s_branch L_evr_mid
L_evl3_mid:
    s_load_dwordx2 s[70:71], s[16:17], 192
    s_mov_b32 s64, 46
    s_branch L_evr_mid
L_evc3_mid:
    s_mov_b32 s64, 0x7fffffff
    s_lshr_b64 s[70:71], s[70:71], 4
    s_and_b32 s54, s69, s71
    s_sub_u32 s55, s70, s68
    s_mov_b32 s68, s70
    s_mov_b32 s69, s71
    s_cmp_lg_u32 s54, 256
    s_cbranch_scc1 L_evr_mid
    s_mov_b32 s72, s68
    s_lshl_b32 s67, s55, 2
    s_mul_i32 s66, s55, 18
    s_mul_i32 s76, s55, 1
    s_mul_i32 s77, s55, 0
    s_mul_i32 s54, s55, 1
    s_ashr_i32 s54, s54, 6
    s_sub_u32 s67, s67, s54
    s_branch L_evr_mid
L_rp_hi:
    v_mov_b32 v92, s74
    v_mov_b32 v93, 0x100
    s_mov_b64 exec, 1
    global_atomic_add_x2 v94, v[92:93], s[16:17] sc1
    s_mov_b64 exec, -1
    s_branch L_rpr_hi
L_ev_hi:
    s_cmp_eq_u32 s64, 1
    s_cbranch_scc1 L_evl0_hi
    s_cmp_eq_u32 s64, 2
    s_cbranch_scc1 L_evc0_hi
    s_cmp_eq_u32 s64, 13
    s_cbranch_scc1 L_evl1_hi
    s_cmp_eq_u32 s64, 14
    s_cbranch_scc1 L_evc1_hi
    s_cmp_eq_u32 s64, 29
    s_cbranch_scc1 L_evl2_hi
    s_cmp_eq_u32 s64, 30
    s_cbranch_scc1 L_evc2_hi
    s_cmp_eq_u32 s64, 45
    s_cbranch_scc1 L_evl3_hi
    s_cmp_eq_u32 s64, 46
    s_cbranch_scc1 L_evc3_hi
    s_branch L_evr_hi
L_evl0_hi:
    s_load_dwordx2 s[68:69], s[16:17], 0
    s_mov_b32 s64, 2
    s_branch L_evr_hi
L_evc0_hi:
    s_mov_b32 s64, 13
    s_lshr_b64 s[68:69], s[68:69], 4
    s_cmp_lg_u32 s69, 256
    s_cbranch_scc1 L_evr_hi
    s_sub_u32 s54, s72, s68
    s_lshl_b32 s55, s54, 6
    s_sub_u32 s66, s66, s55
    s_branch L_evr_hi
L_evl1_hi:
    s_load_dwordx2 s[68:69], s[16:17], 136
    s_load_dwordx2 s[70:71], s[16:17], 128
    s_mov_b32 s64, 14
    s_branch L_evr_hi
L_evc1_hi:
    s_mov_b32 s64, 29
    s_lshr_b64 s[68:69], s[68:69], 4
    s_lshr_b64 s[70:71], s[70:71], 4
    s_and_b32 s54, s69, s71
    s_sub_u32 s55, s70, s68
    s_mov_b32 s68, s70
    s_mov_b32 s69, s71
    s_cmp_lg_u32 s54, 256
    s_cbranch_scc1 L_evr_hi
    s_lshl_b32 s55, s55, 1
    s_mov_b32 s72, s68
    s_lshl_b32 s67, s55, 2
    s_mul_i32 s66, s55, 18
    s_mul_i32 s76, s55, 1
    s_mul_i32 s77, s55, 0
    s_mul_i32 s54, s55, 1
    s_ashr_i32 s54, s54, 6
    s_sub_u32 s67, s67, s54
    s_branch L_evr_hi
L_evl2_hi:
    s_load_dwordx2 s[70:71], s[16:17], 64
    s_mov_b32 s64, 30
    s_branch L_evr_hi
L_evc2_hi:
    s_mov_b32 s64, 45
    s_lshr_b64 s[70:71], s[70:71], 4
    s_and_b32 s54, s69, s71
    s_sub_u32 s55, s70, s68
    s_mov_b32 s68, s70
    s_mov_b32 s69, s71
    s_cmp_lg_u32 s54, 256
    s_cbranch_scc1 L_evr_hi
    s_mov_b32 s72, s68
    s_lshl_b32 s67, s55, 2
    s_mul_i32 s66, s55, 18
    s_mul_i32 s76, s55, 1
    s_mul_i32 s77, s55, 0
    s_mul_i32 s54, s55, 1
    s_ashr_i32 s54, s54, 6
    s_sub_u32 s67, s67, s54
    s_branch L_evr_hi
L_evl3_hi:
    s_load_dwordx2 s[70:71], s[16:17], 192
    s_mov_b32 s64, 46
    s_branch L_evr_hi
L_evc3_hi:
    s_mov_b32 s64, 0x7fffffff
    s_lshr_b64 s[70:71], s[70:71], 4
    s_and_b32 s54, s69, s71
    s_sub_u32 s55, s70, s68
    s_mov_b32 s68, s70
    s_mov_b32 s69, s71
    s_cmp_lg_u32 s54, 256
    s_cbranch_scc1 L_evr_hi
    s_mov_b32 s72, s68
    s_lshl_b32 s67, s55, 2
    s_mul_i32 s66, s55, 18
    s_mul_i32 s76, s55, 1
    s_mul_i32 s77, s55, 0
    s_mul_i32 s54, s55, 1
    s_ashr_i32 s54, s54, 6
    s_sub_u32 s67, s67, s54
    s_branch L_evr_hi
L_rp_lo:
    v_mov_b32 v92, s74
    v_mov_b32 v93, 0x100
    s_mov_b64 exec, 1
    global_atomic_add_x2 v94, v[92:93], s[16:17] sc1
    s_mov_b64 exec, -1
    s_branch L_rpr_lo
L_ev_lo:
    s_cmp_eq_u32 s64, 1
    s_cbranch_scc1 L_evl0_lo
    s_cmp_eq_u32 s64, 2
    s_cbranch_scc1 L_evc0_lo
    s_cmp_eq_u32 s64, 13
    s_cbranch_scc1 L_evl1_lo
    s_cmp_eq_u32 s64, 14
    s_cbranch_scc1 L_evc1_lo
    s_cmp_eq_u32 s64, 29
    s_cbranch_scc1 L_evl2_lo
    s_cmp_eq_u32 s64, 30
    s_cbranch_scc1 L_evc2_lo
    s_cmp_eq_u32 s64, 45
    s_cbranch_scc1 L_evl3_lo
    s_cmp_eq_u32 s64, 46
    s_cbranch_scc1 L_evc3_lo
    s_branch L_evr_lo
L_evl0_lo:
    s_load_dwordx2 s[68:69], s[16:17], 0
    s_mov_b32 s64, 2
    s_branch L_evr_lo
L_evc0_lo:
    s_mov_b32 s64, 13
    s_lshr_b64 s[68:69], s[68:69], 4
    s_cmp_lg_u32 s69, 256
    s_cbranch_scc1 L_evr_lo
    s_sub_u32 s54, s72, s68
    s_lshl_b32 s55, s54, 6
    s_sub_u32 s66, s66, s55
    s_branch L_evr_lo
L_evl1_lo:
    s_load_dwordx2 s[68:69], s[16:17], 136
    s_load_dwordx2 s[70:71], s[16:17], 128
    s_mov_b32 s64, 14
    s_branch L_evr_lo
L_evc1_lo:
    s_mov_b32 s64, 29
    s_lshr_b64 s[68:69], s[68:69], 4
    s_lshr_b64 s[70:71], s[70:71], 4
    s_and_b32 s54, s69, s71
    s_sub_u32 s55, s70, s68
    s_mov_b32 s68, s70
    s_mov_b32 s69, s71
    s_cmp_lg_u32 s54, 256
    s_cbranch_scc1 L_evr_lo
    s_lshl_b32 s55, s55, 1
    s_mov_b32 s72, s68
    s_lshl_b32 s67, s55, 2
    s_mul_i32 s66, s55, 18
    s_mul_i32 s76, s55, 1
    s_mul_i32 s77, s55, 0
    s_mul_i32 s54, s55, 1
    s_ashr_i32 s54, s54, 6
    s_sub_u32 s67, s67, s54
    s_branch L_evr_lo
L_evl2_lo:
    s_load_dwordx2 s[70:71], s[16:17], 64
    s_mov_b32 s64, 30
    s_branch L_evr_lo
L_evc2_lo:
    s_mov_b32 s64, 45
    s_lshr_b64 s[70:71], s[70:71], 4
    s_and_b32 s54, s69, s71
    s_sub_u32 s55, s70, s68
    s_mov_b32 s68, s70
    s_mov_b32 s69, s71
    s_cmp_lg_u32 s54, 256
    s_cbranch_scc1 L_evr_lo
    s_mov_b32 s72, s68
    s_lshl_b32 s67, s55, 2
    s_mul_i32 s66, s55, 18
    s_mul_i32 s76, s55, 1
    s_mul_i32 s77, s55, 0
    s_mul_i32 s54, s55, 1
    s_ashr_i32 s54, s54, 6
    s_sub_u32 s67, s67, s54
    s_branch L_evr_lo
L_evl3_lo:
    s_load_dwordx2 s[70:71], s[16:17], 192
    s_mov_b32 s64, 46
    s_branch L_evr_lo
L_evc3_lo:
    s_mov_b32 s64, 0x7fffffff
    s_lshr_b64 s[70:71], s[70:71], 4
    s_and_b32 s54, s69, s71
    s_sub_u32 s55, s70, s68
    s_mov_b32 s68, s70
    s_mov_b32 s69, s71
    s_cmp_lg_u32 s54, 256
    s_cbranch_scc1 L_evr_lo
    s_mov_b32 s72, s68
    s_lshl_b32 s67, s55, 2
    s_mul_i32 s66, s55, 18
    s_mul_i32 s76, s55, 1
    s_mul_i32 s77, s55, 0
    s_mul_i32 s54, s55, 1
    s_ashr_i32 s54, s54, 6
    s_sub_u32 s67, s67, s54
    s_branch L_evr_lo
L_rp_ihK:
    v_mov_b32 v92, s74
    v_mov_b32 v93, 0x100
    s_mov_b64 exec, 1
    global_atomic_add_x2 v94, v[92:93], s[16:17] sc1
    s_mov_b64 exec, -1
    s_branch L_rpr_ihK
L_ev_ihK:
    s_cmp_eq_u32 s64, 1
    s_cbranch_scc1 L_evl0_ihK
    s_cmp_eq_u32 s64, 2
    s_cbranch_scc1 L_evc0_ihK
    s_cmp_eq_u32 s64, 13
    s_cbranch_scc1 L_evl1_ihK
    s_cmp_eq_u32 s64, 14
    s_cbranch_scc1 L_evc1_ihK
    s_cmp_eq_u32 s64, 29
    s_cbranch_scc1 L_evl2_ihK
    s_cmp_eq_u32 s64, 30
    s_cbranch_scc1 L_evc2_ihK
    s_cmp_eq_u32 s64, 45
    s_cbranch_scc1 L_evl3_ihK
    s_cmp_eq_u32 s64, 46
    s_cbranch_scc1 L_evc3_ihK
    s_branch L_evr_ihK
L_evl0_ihK:
    s_load_dwordx2 s[68:69], s[16:17], 0
    s_mov_b32 s64, 2
    s_branch L_evr_ihK
L_evc0_ihK:
    s_mov_b32 s64, 13
    s_lshr_b64 s[68:69], s[68:69], 4
    s_cmp_lg_u32 s69, 256
    s_cbranch_scc1 L_evr_ihK
    s_sub_u32 s54, s72, s68
    s_lshl_b32 s55, s54, 6
    s_sub_u32 s66, s66, s55
    s_branch L_evr_ihK
L_evl1_ihK:
    s_load_dwordx2 s[68:69], s[16:17], 136
    s_load_dwordx2 s[70:71], s[16:17], 128
    s_mov_b32 s64, 14
    s_branch L_evr_ihK
L_evc1_ihK:
    s_mov_b32 s64, 29
    s_lshr_b64 s[68:69], s[68:69], 4
    s_lshr_b64 s[70:71], s[70:71], 4
    s_and_b32 s54, s69, s71
    s_sub_u32 s55, s70, s68
    s_mov_b32 s68, s70
    s_mov_b32 s69, s71
    s_cmp_lg_u32 s54, 256
    s_cbranch_scc1 L_evr_ihK
    s_lshl_b32 s55, s55, 1
    s_mov_b32 s72, s68
    s_lshl_b32 s67, s55, 2
    s_mul_i32 s66, s55, 18
    s_mul_i32 s76, s55, 1
    s_mul_i32 s77, s55, 0
    s_mul_i32 s54, s55, 1
    s_ashr_i32 s54, s54, 6
    s_sub_u32 s67, s67, s54
    s_branch L_evr_ihK
L_evl2_ihK:
    s_load_dwordx2 s[70:71], s[16:17], 64
    s_mov_b32 s64, 30
    s_branch L_evr_ihK
L_evc2_ihK:
    s_mov_b32 s64, 45
    s_lshr_b64 s[70:71], s[70:71], 4
    s_and_b32 s54, s69, s71
    s_sub_u32 s55, s70, s68
    s_mov_b32 s68, s70
    s_mov_b32 s69, s71
    s_cmp_lg_u32 s54, 256
    s_cbranch_scc1 L_evr_ihK
    s_mov_b32 s72, s68
    s_lshl_b32 s67, s55, 2
    s_mul_i32 s66, s55, 18
    s_mul_i32 s76, s55, 1
    s_mul_i32 s77, s55, 0
    s_mul_i32 s54, s55, 1
    s_ashr_i32 s54, s54, 6
    s_sub_u32 s67, s67, s54
    s_branch L_evr_ihK
L_evl3_ihK:
    s_load_dwordx2 s[70:71], s[16:17], 192
    s_mov_b32 s64, 46
    s_branch L_evr_ihK
L_evc3_ihK:
    s_mov_b32 s64, 0x7fffffff
    s_lshr_b64 s[70:71], s[70:71], 4
    s_and_b32 s54, s69, s71
    s_sub_u32 s55, s70, s68
    s_mov_b32 s68, s70
    s_mov_b32 s69, s71
    s_cmp_lg_u32 s54, 256
    s_cbranch_scc1 L_evr_ihK
    s_mov_b32 s72, s68
    s_lshl_b32 s67, s55, 2
    s_mul_i32 s66, s55, 18
    s_mul_i32 s76, s55, 1
    s_mul_i32 s77, s55, 0
    s_mul_i32 s54, s55, 1
    s_ashr_i32 s54, s54, 6
    s_sub_u32 s67, s67, s54
    s_branch L_evr_ihK
L_rp_ihV:
    v_mov_b32 v92, s74
    v_mov_b32 v93, 0x100
    s_mov_b64 exec, 1
    global_atomic_add_x2 v94, v[92:93], s[16:17] sc1
    s_mov_b64 exec, -1
    s_branch L_rpr_ihV
L_ev_ihV:
    s_cmp_eq_u32 s64, 1
    s_cbranch_scc1 L_evl0_ihV
    s_cmp_eq_u32 s64, 2
    s_cbranch_scc1 L_evc0_ihV
    s_cmp_eq_u32 s64, 13
    s_cbranch_scc1 L_evl1_ihV
    s_cmp_eq_u32 s64, 14
    s_cbranch_scc1 L_evc1_ihV
    s_cmp_eq_u32 s64, 29
    s_cbranch_scc1 L_evl2_ihV
    s_cmp_eq_u32 s64, 30
    s_cbranch_scc1 L_evc2_ihV
    s_cmp_eq_u32 s64, 45
    s_cbranch_scc1 L_evl3_ihV
    s_cmp_eq_u32 s64, 46
    s_cbranch_scc1 L_evc3_ihV
    s_branch L_evr_ihV
L_evl0_ihV:
    s_load_dwordx2 s[68:69], s[16:17], 0
    s_mov_b32 s64, 2
    s_branch L_evr_ihV
L_evc0_ihV:
    s_mov_b32 s64, 13
    s_lshr_b64 s[68:69], s[68:69], 4
    s_cmp_lg_u32 s69, 256
    s_cbranch_scc1 L_evr_ihV
    s_sub_u32 s54, s72, s68
    s_lshl_b32 s55, s54, 6
    s_sub_u32 s66, s66, s55
    s_branch L_evr_ihV
L_evl1_ihV:
    s_load_dwordx2 s[68:69], s[16:17], 136
    s_load_dwordx2 s[70:71], s[16:17], 128
    s_mov_b32 s64, 14
    s_branch L_evr_ihV
L_evc1_ihV:
    s_mov_b32 s64, 29
    s_lshr_b64 s[68:69], s[68:69], 4
    s_lshr_b64 s[70:71], s[70:71], 4
    s_and_b32 s54, s69, s71
    s_sub_u32 s55, s70, s68
    s_mov_b32 s68, s70
    s_mov_b32 s69, s71
    s_cmp_lg_u32 s54, 256
    s_cbranch_scc1 L_evr_ihV
    s_lshl_b32 s55, s55, 1
    s_mov_b32 s72, s68
    s_lshl_b32 s67, s55, 2
    s_mul_i32 s66, s55, 18
    s_mul_i32 s76, s55, 1
    s_mul_i32 s77, s55, 0
    s_mul_i32 s54, s55, 1
    s_ashr_i32 s54, s54, 6
    s_sub_u32 s67, s67, s54
    s_branch L_evr_ihV
L_evl2_ihV:
    s_load_dwordx2 s[70:71], s[16:17], 64
    s_mov_b32 s64, 30
    s_branch L_evr_ihV
L_evc2_ihV:
    s_mov_b32 s64, 45
    s_lshr_b64 s[70:71], s[70:71], 4
    s_and_b32 s54, s69, s71
    s_sub_u32 s55, s70, s68
    s_mov_b32 s68, s70
    s_mov_b32 s69, s71
    s_cmp_lg_u32 s54, 256
    s_cbranch_scc1 L_evr_ihV
    s_mov_b32 s72, s68
    s_lshl_b32 s67, s55, 2
    s_mul_i32 s66, s55, 18
    s_mul_i32 s76, s55, 1
    s_mul_i32 s77, s55, 0
    s_mul_i32 s54, s55, 1
    s_ashr_i32 s54, s54, 6
    s_sub_u32 s67, s67, s54
    s_branch L_evr_ihV
L_evl3_ihV:
    s_load_dwordx2 s[70:71], s[16:17], 192
    s_mov_b32 s64, 46
    s_branch L_evr_ihV
L_evc3_ihV:
    s_mov_b32 s64, 0x7fffffff
    s_lshr_b64 s[70:71], s[70:71], 4
    s_and_b32 s54, s69, s71
    s_sub_u32 s55, s70, s68
    s_mov_b32 s68, s70
    s_mov_b32 s69, s71
    s_cmp_lg_u32 s54, 256
    s_cbranch_scc1 L_evr_ihV
    s_mov_b32 s72, s68
    s_lshl_b32 s67, s55, 2
    s_mul_i32 s66, s55, 18
    s_mul_i32 s76, s55, 1
    s_mul_i32 s77, s55, 0
    s_mul_i32 s54, s55, 1
    s_ashr_i32 s54, s54, 6
    s_sub_u32 s67, s67, s54
    s_branch L_evr_ihV
L_fin:
L_end:
    s_endpgm
.section .rodata,"a"
.p2align 6
.amdhsa_kernel standalone__low_rank_proj_linformer__sampling_kernel
  .amdhsa_next_free_vgpr 264
  .amdhsa_next_free_sgpr 88
  .amdhsa_accum_offset 228
  .amdhsa_group_segment_fixed_size 0
  .amdhsa_kernarg_size 64
  .amdhsa_user_sgpr_count 2
  .amdhsa_user_sgpr_kernarg_segment_ptr 1
  .amdhsa_system_sgpr_workgroup_id_x 1
  .amdhsa_float_denorm_mode_32 3
.end_amdhsa_kernel
```
